```python
import torch

def _softmax(x, axis=-1):
    return torch.softmax(x, dim=axis)
def _gelu(x):
    return torch.nn.functional.gelu(x, approximate="tanh")
def _silu(x):
    return torch.nn.functional.silu(x)
def _sigmoid(x):
    return torch.sigmoid(x)
def _layernorm(x, axis=-1, eps=1e-5):
    m = x.mean(dim=axis, keepdim=True)
    v = x.var(dim=axis, keepdim=True, unbiased=False)
    return (x - m) / torch.sqrt(v + eps)
def _scatter_add(tgt, idx, src, axis=0):
    return tgt.clone().index_add_(axis, idx, src)
def _segment_sum(src, seg, n):
    out = torch.zeros((n,) + src.shape[1:], dtype=src.dtype)
    return out.index_add_(0, seg, src)
def _pad(x, pw):
    flat = tuple(v for pair in reversed(pw) for v in pair)
    return torch.nn.functional.pad(x, flat)

kernel_name = 'standalone__kv_cache_quant_int4_int2_kv_with_per_channel_or_per_token_scales__prompt'

def setup_inputs():

    _w = (lambda a: (lambda t: t.to(torch.bfloat16) if t.is_floating_point() else t)(torch.as_tensor(a)))
    B = 1
    Sq = 2048
    Skv = 2048
    Hq = 32
    Hkv = 32
    Dh = 128
    bits = 2
    G = 64
    if G <= 0 or G >= Skv:
        G = max(1, Skv // 2)
    Skv = (Skv // G) * G
    ngk = Skv // G
    qmax = (1 << bits) - 1
    return {
        "q": _w((lambda *s: torch.randn(*s, dtype=torch.bfloat16) * 1.6)(B, Hq, Sq, Dh)),
        "qk": _w(torch.randint(0, qmax + 1, (B, Hkv, Skv, Dh)).to(torch.int32)),
        "qv": _w(torch.randint(0, qmax + 1, (B, Hkv, Skv, Dh)).to(torch.int32)),
        "k_scales": _w(torch.abs((lambda *s: torch.randn(*s, dtype=torch.bfloat16) * 1.6)(B, Hkv, ngk, Dh)) * 0.05 + 0.02),
        "k_zeros": _w((lambda *s: torch.randn(*s, dtype=torch.bfloat16) * 1.6)(B, Hkv, ngk, Dh) + float(qmax) / 2.0),
        "v_scales": _w(torch.abs((lambda *s: torch.randn(*s, dtype=torch.bfloat16) * 0.05)(B, Hkv, Skv, 1)) * 0.05 + 0.02),
        "v_zeros": _w((lambda *s: torch.randn(*s, dtype=torch.bfloat16) * 0.05)(B, Hkv, Skv, 1) + float(qmax) / 2.0),
    }

def reference(q, qk, qv, k_scales, k_zeros, v_scales, v_zeros):
    B, Hq, Sq, Dh = q.shape
    Hkv, Skv = qk.shape[1], qk.shape[2]
    ngk = k_scales.shape[2]
    G = Skv // ngk
    ks = (lambda x, n, axis: torch.repeat_interleave(x, n, dim=axis))(k_scales, G, axis=2)
    kz = (lambda x, n, axis: torch.repeat_interleave(x, n, dim=axis))(k_zeros, G, axis=2)
    k = ((lambda x, dt: x.to(dt))(qk, q.dtype) - kz) * ks
    v = ((lambda x, dt: x.to(dt))(qv, q.dtype) - v_zeros) * v_scales
    rep = Hq // Hkv
    if rep > 1:
        k = (lambda x, n, axis: torch.repeat_interleave(x, n, dim=axis))(k, rep, axis=1)
        v = (lambda x, n, axis: torch.repeat_interleave(x, n, dim=axis))(v, rep, axis=1)
    scale = float(Dh) ** -0.5
    logits = torch.einsum("bhqd,bhkd->bhqk", q, k) * scale
    p = _softmax(logits, axis=-1)
    o = torch.einsum("bhqk,bhkd->bhqd", p, v)
    return o
```

```asm
; @launch grid=(256,1,1) block=(256,1,1) lds=156160
.amdgcn_target "amdgcn-amd-amdhsa--gfx950"
.text
.globl standalone__kv_cache_quant_int4_int2_kv_with_per_channel_or_per_token_scales__prompt_kernel
.p2align 8
.type standalone__kv_cache_quant_int4_int2_kv_with_per_channel_or_per_token_scales__prompt_kernel,@function
standalone__kv_cache_quant_int4_int2_kv_with_per_channel_or_per_token_scales__prompt_kernel:
    s_cmp_ge_u32 s2, 256
    s_cbranch_scc1 L_end
    s_load_dwordx16 s[4:19], s[0:1], 0
    v_lshrrev_b32 v160, 6, v0
    v_and_b32 v11, 63, v0
    v_readfirstlane_b32 s58, v160
    s_getpc_b64 s[74:75]
L_pc:
    v_lshlrev_b32 v161, 7, v0
    v_min_u32 v161, L_slow-L_pc, v161
    global_load_dword v28, v161, s[74:75]
    s_and_b32 s61, s2, 7
    s_lshr_b32 s62, s2, 3
    s_and_b32 s63, s62, 3
    s_lshl_b32 s61, s61, 2
    s_add_u32 s59, s61, s63
    s_lshr_b32 s60, s62, 2
    s_movk_i32 s73, 0x1000
    s_mov_b32 s56, s60
    s_and_b32 s56, s56, 3
    s_lshl_b32 s56, s56, 12
    s_xor_b32 s65, s56, 4096
    s_xor_b32 s66, s56, 8192
    s_xor_b32 s67, s56, 12288
    s_mov_b32 s23, 0x20000
    s_mov_b32 s27, 0x20000
    s_mov_b32 s31, 0x20000
    s_mov_b32 s35, 0x20000
    s_mov_b32 s39, 0x20000
    s_mov_b32 s43, 0x20000
    s_mov_b32 s47, 0x20000
    s_mov_b32 s51, 0x20000
    s_mov_b32 s22, 65536
    s_mov_b32 s26, 1048576
    s_mov_b32 s30, 1048576
    s_mov_b32 s34, 65536
    s_mov_b32 s38, 8192
    s_mov_b32 s42, 8192
    s_mov_b32 s46, 4096
    s_mov_b32 s50, 4096
    v_lshlrev_b32 v162, 4, v0
    s_lshl_b32 s61, s58, 13
    v_lshl_add_u32 v1, v11, 4, s61
    v_add_u32 v2, 0x1000, v1
    v_lshrrev_b32 v163, 4, v11
    v_and_b32 v164, 15, v0
    v_xor_b32 v9, v164, v163
    v_lshlrev_b32 v9, 4, v9
    v_lshl_add_u32 v9, v163, 8, v9
    s_lshl_b32 s61, s58, 14
    v_add_u32 v9, s61, v9
    v_xor_b32 v10, 64, v9
    s_mul_i32 s64, s58, 12288
    s_add_u32 s64, s64, 107008
    s_lshl_b32 s70, s59, 13
    s_lshl_b32 s71, s59, 12
    s_lshl_b32 s72, s59, 20
    s_lshl_b32 s61, s59, 19
    s_lshl_b32 s62, s60, 16
    s_add_u32 s61, s61, s62
    s_waitcnt lgkmcnt(0)
    s_add_u32 s24, s6, s72
    s_addc_u32 s25, s7, 0
    s_add_u32 s20, s4, s61
    s_addc_u32 s21, s5, 0
    s_add_u32 s28, s8, s72
    s_addc_u32 s29, s9, 0
    s_add_u32 s36, s10, s70
    s_addc_u32 s37, s11, 0
    buffer_load_dwordx4 v[96:99], v162, s[36:39], 0 offen nt
    buffer_load_dwordx4 v[100:103], v162, s[36:39], s73 offen nt
    s_add_u32 s44, s14, s71
    s_addc_u32 s45, s15, 0
    buffer_load_dwordx4 v[112:115], v162, s[44:47], 0 offen nt
    s_add_u32 s48, s16, s71
    s_addc_u32 s49, s17, 0
    buffer_load_dwordx4 v[116:119], v162, s[48:51], 0 offen nt
    s_add_u32 s40, s12, s70
    s_addc_u32 s41, s13, 0
    buffer_load_dwordx4 v[104:107], v162, s[40:43], 0 offen nt
    buffer_load_dwordx4 v[108:111], v162, s[40:43], s73 offen nt
    s_add_u32 m0, s64, 0
    s_nop 0
    buffer_load_dwordx4 v9, s[20:23], s67 offen nt lds
    buffer_load_dwordx4 v10, s[20:23], s67 offen offset:1024 nt lds
    buffer_load_dwordx4 v9, s[20:23], s67 offen offset:2048 nt lds
    buffer_load_dwordx4 v10, s[20:23], s67 offen offset:3072 nt lds
    tbuffer_load_format_d16_xyzw v[224:225], v1, s[24:27], 0 format:[BUF_DATA_FORMAT_32_32_32_32,BUF_NUM_FORMAT_UINT] offen nt
    tbuffer_load_format_d16_xyzw v[226:227], v1, s[24:27], 0 format:[BUF_DATA_FORMAT_32_32_32_32,BUF_NUM_FORMAT_UINT] offen offset:1024 nt
    tbuffer_load_format_d16_xyzw v[228:229], v1, s[24:27], 0 format:[BUF_DATA_FORMAT_32_32_32_32,BUF_NUM_FORMAT_UINT] offen offset:2048 nt
    tbuffer_load_format_d16_xyzw v[230:231], v1, s[24:27], 0 format:[BUF_DATA_FORMAT_32_32_32_32,BUF_NUM_FORMAT_UINT] offen offset:3072 nt
    s_add_u32 s32, s18, s61
    s_addc_u32 s33, s19, 0
    s_cmp_lt_u32 s58, 2
    s_mov_b32 s62, 0x1000000
    s_cselect_b32 s62, s62, 0xffffc000
    v_add_u32 v167, s62, v1
    v_add_u32 v168, s62, v2
    s_mov_b32 s55, 15
    s_and_b32 s61, s58, 1
    s_lshr_b32 s62, s58, 1
    s_lshl_b32 s61, s61, 11
    s_lshl_b32 s62, s62, 10
    s_add_u32 s52, s61, s62
    v_bfe_u32 v165, v0, 1, 2
    v_mul_u32_u24 v3, 4112, v165
    v_bfe_u32 v165, v0, 3, 1
    v_lshl_add_u32 v3, v165, 11, v3
    v_bfe_u32 v165, v0, 0, 1
    v_lshl_add_u32 v3, v165, 7, v3
    v_bfe_u32 v165, v0, 4, 1
    v_lshl_add_u32 v3, v165, 6, v3
    v_bfe_u32 v165, v0, 5, 1
    v_lshl_add_u32 v3, v165, 5, v3
    v_bfe_u32 v165, v0, 3, 2
    v_mul_u32_u24 v4, 4128, v165
    v_bfe_u32 v165, v0, 5, 1
    v_lshl_add_u32 v4, v165, 11, v4
    v_bfe_u32 v165, v0, 2, 1
    v_lshl_add_u32 v4, v165, 7, v4
    v_bfe_u32 v165, v0, 0, 2
    v_lshl_add_u32 v4, v165, 3, v4
    v_add_u32 v4, 32896, v4
    v_bfe_u32 v165, v0, 4, 1
    v_lshlrev_b32 v165, 3, v165
    v_bfe_u32 v166, v0, 5, 1
    v_lshl_add_u32 v165, v166, 2, v165
    v_and_b32 v166, 7, v0
    v_xor_b32 v165, v165, v166
    v_lshlrev_b32 v165, 4, v165
    v_lshl_add_u32 v165, v164, 8, v165
    v_add_u32 v170, s64, v165
    v_xor_b32 v171, 16, v170
    v_xor_b32 v172, 32, v170
    v_xor_b32 v173, 48, v170
    v_lshlrev_b32 v5, 5, v163
    v_add_u32 v5, 82304, v5
    v_and_b32 v8, 0x1f0, v162
    v_add_u32 v8, 65920, v8
    v_and_b32 v165, 7, v0
    v_lshlrev_b32 v165, 6, v165
    v_lshl_add_u32 v6, v163, 4, v165
    v_add_u32 v6, 89984, v6
    v_and_b32 v165, 1, v0
    v_mul_u32_u24 v165, 0xaaaa, v165
    v_add_u32 v31, 0x4444, v165
    v_lshlrev_b32 v174, 5, v0
    v_add_u32 v174, 65920, v174
    v_lshlrev_b32 v175, 5, v0
    v_add_u32 v175, 82304, v175
    v_lshrrev_b32 v176, 3, v0
    v_lshlrev_b32 v176, 9, v176
    v_and_b32 v177, 7, v0
    v_lshl_add_u32 v176, v177, 3, v176
    v_add_u32 v176, 90496, v176
    v_mov_b32 v124, 0x3f803f80
    v_mov_b32 v125, 0x3f803f80
    v_mov_b32 v126, 0x3f803f80
    v_mov_b32 v127, 0x3f803f80
    ds_write2_b32 v176, v124, v126 offset0:32 offset1:33
    ds_write2_b32 v176, v125, v127 offset0:48 offset1:49
    s_mov_b32 s72, 0xffff0000
    v_mov_b32 v212, 0
    v_mov_b32 v213, 0
    v_mov_b32 v214, 0
    v_mov_b32 v215, 0
    v_mov_b32 v244, 0
    v_mov_b32 v245, 0
    v_mov_b32 v246, 0
    v_mov_b32 v247, 0
    v_accvgpr_write_b32 a24, 0
    v_accvgpr_write_b32 a25, 0
    v_accvgpr_write_b32 a26, 0
    v_accvgpr_write_b32 a27, 0
    v_accvgpr_write_b32 a28, 0
    v_accvgpr_write_b32 a29, 0
    v_accvgpr_write_b32 a30, 0
    v_accvgpr_write_b32 a31, 0
    v_mov_b32 v188, 0
    v_mov_b32 v189, 0
    v_mov_b32 v190, 0
    v_mov_b32 v191, 0
    v_mov_b32 v216, 0
    v_mov_b32 v217, 0
    v_mov_b32 v218, 0
    v_mov_b32 v219, 0
    v_mov_b32 v220, 0
    v_mov_b32 v221, 0
    v_mov_b32 v222, 0
    v_mov_b32 v223, 0
    v_mov_b32 v252, 0
    v_mov_b32 v253, 0
    v_mov_b32 v254, 0
    v_mov_b32 v255, 0
    v_mov_b32 v248, 0
    v_mov_b32 v249, 0
    v_mov_b32 v250, 0
    v_mov_b32 v251, 0
    v_accvgpr_write_b32 a32, 0
    v_accvgpr_write_b32 a33, 0
    v_accvgpr_write_b32 a34, 0
    v_accvgpr_write_b32 a35, 0
    v_accvgpr_write_b32 a36, 0
    v_accvgpr_write_b32 a37, 0
    v_accvgpr_write_b32 a38, 0
    v_accvgpr_write_b32 a39, 0
    v_accvgpr_write_b32 a40, 0
    v_accvgpr_write_b32 a41, 0
    v_accvgpr_write_b32 a42, 0
    v_accvgpr_write_b32 a43, 0
    v_accvgpr_write_b32 a44, 0
    v_accvgpr_write_b32 a45, 0
    v_accvgpr_write_b32 a46, 0
    v_accvgpr_write_b32 a47, 0
    s_waitcnt vmcnt(13)
    v_lshlrev_b32 v128, 16, v96
    v_and_b32 v129, s72, v96
    v_lshlrev_b32 v130, 16, v97
    v_and_b32 v131, s72, v97
    v_lshlrev_b32 v132, 16, v98
    v_and_b32 v133, s72, v98
    v_lshlrev_b32 v134, 16, v99
    v_and_b32 v135, s72, v99
    s_waitcnt vmcnt(12)
    v_lshlrev_b32 v136, 16, v100
    v_and_b32 v137, s72, v100
    v_lshlrev_b32 v138, 16, v101
    v_and_b32 v139, s72, v101
    v_lshlrev_b32 v140, 16, v102
    v_and_b32 v141, s72, v102
    tbuffer_load_format_d16_xyzw v[232:233], v2, s[24:27], 0 format:[BUF_DATA_FORMAT_32_32_32_32,BUF_NUM_FORMAT_UINT] offen nt
    v_lshlrev_b32 v142, 16, v103
    v_and_b32 v143, s72, v103
    v_max3_f32 v165, abs(v128), abs(v129), abs(v130)
    v_max3_f32 v165, v165, abs(v131), abs(v132)
    v_max3_f32 v165, v165, abs(v133), abs(v134)
    v_max3_f32 v165, v165, abs(v135), abs(v136)
    v_max3_f32 v165, v165, abs(v137), abs(v138)
    v_max3_f32 v165, v165, abs(v139), abs(v140)
    v_max3_f32 v165, v165, abs(v141), abs(v142)
    v_max_f32_e64 v165, v165, abs(v143)
    s_nop 1
    v_max_f32_dpp v165, v165, v165 row_ror:1 row_mask:0xf bank_mask:0xf
    s_nop 1
    v_max_f32_dpp v165, v165, v165 row_ror:2 row_mask:0xf bank_mask:0xf
    s_nop 1
    v_max_f32_dpp v165, v165, v165 row_ror:4 row_mask:0xf bank_mask:0xf
    s_nop 1
    v_max_f32_dpp v165, v165, v165 row_ror:8 row_mask:0xf bank_mask:0xf
    tbuffer_load_format_d16_xyzw v[234:235], v2, s[24:27], 0 format:[BUF_DATA_FORMAT_32_32_32_32,BUF_NUM_FORMAT_UINT] offen offset:1024 nt
    v_mov_b32 v166, v165
    s_nop 1
    v_permlane16_swap_b32 v165, v166
    v_max_f32 v165, v165, v166
    v_mov_b32 v166, v165
    s_nop 1
    v_permlane32_swap_b32 v165, v166
    v_max_f32 v165, v165, v166
    s_lshl_b32 s61, s58, 2
    s_add_u32 s61, s61, 106880
    v_mov_b32 v166, s61
    ds_write_b32 v166, v165
    s_waitcnt vmcnt(12)
    ds_write2_b32 v176, v116, v118 offset0:0 offset1:1
    tbuffer_load_format_d16_xyzw v[236:237], v2, s[24:27], 0 format:[BUF_DATA_FORMAT_32_32_32_32,BUF_NUM_FORMAT_UINT] offen offset:2048 nt
    ds_write2_b32 v176, v117, v119 offset0:16 offset1:17
    v_lshlrev_b32 v80, 16, v112
    v_and_b32 v81, s72, v112
    v_lshlrev_b32 v82, 16, v113
    v_and_b32 v83, s72, v113
    v_lshlrev_b32 v84, 16, v114
    v_and_b32 v85, s72, v114
    v_lshlrev_b32 v86, 16, v115
    v_and_b32 v87, s72, v115
    v_log_f32 v88, v80
    v_log_f32 v89, v81
    tbuffer_load_format_d16_xyzw v[238:239], v2, s[24:27], 0 format:[BUF_DATA_FORMAT_32_32_32_32,BUF_NUM_FORMAT_UINT] offen offset:3072 nt
    v_log_f32 v90, v82
    v_log_f32 v91, v83
    v_log_f32 v92, v84
    v_log_f32 v93, v85
    v_log_f32 v94, v86
    v_log_f32 v95, v87
    v_rcp_f32 v120, v80
    s_add_u32 m0, s64, 4096
    s_nop 0
    buffer_load_dwordx4 v9, s[20:23], s66 offen nt lds
    v_rcp_f32 v121, v81
    v_rcp_f32 v122, v82
    v_rcp_f32 v123, v83
    v_rcp_f32 v124, v84
    v_rcp_f32 v125, v85
    v_rcp_f32 v126, v86
    v_rcp_f32 v127, v87
    buffer_load_dwordx4 v10, s[20:23], s66 offen offset:1024 nt lds
    v_min3_f32 v12, v88, v89, v90
    v_max3_f32 v13, v88, v89, v90
    v_min3_f32 v12, v12, v91, v92
    v_max3_f32 v13, v13, v91, v92
    v_min3_f32 v12, v12, v93, v94
    v_max3_f32 v13, v13, v93, v94
    v_min_f32 v12, v12, v95
    v_max_f32 v13, v13, v95
    v_mov_b32 v14, 0x7fc00000
    v_cmp_le_f32 vcc, 0xc2200000, v12
    s_mov_b32 s70, 0x2b800000
    s_mov_b32 s71, 0x42b40000
    v_pk_mul_f32 v[120:121], v[120:121], s[70:71] op_sel_hi:[1,0]
    v_pk_mul_f32 v[122:123], v[122:123], s[70:71] op_sel_hi:[1,0]
    buffer_load_dwordx4 v9, s[20:23], s66 offen offset:2048 nt lds
    v_pk_mul_f32 v[124:125], v[124:125], s[70:71] op_sel_hi:[1,0]
    v_pk_mul_f32 v[126:127], v[126:127], s[70:71] op_sel_hi:[1,0]
    v_cndmask_b32 v88, v14, v88, vcc
    v_cmp_ge_f32 vcc, 0x41a00000, v13
    v_cvt_pk_bf16_f32 v20, v120, v121
    v_cvt_pk_bf16_f32 v21, v122, v123
    v_cvt_pk_bf16_f32 v22, v124, v125
    v_cvt_pk_bf16_f32 v23, v126, v127
    v_cndmask_b32 v88, v14, v88, vcc
    v_pk_add_f32 v[88:89], v[88:89], s[70:71] op_sel:[0,1] op_sel_hi:[1,1]
    v_pk_add_f32 v[90:91], v[90:91], s[70:71] op_sel:[0,1] op_sel_hi:[1,1]
    v_pk_add_f32 v[92:93], v[92:93], s[70:71] op_sel:[0,1] op_sel_hi:[1,1]
    v_pk_add_f32 v[94:95], v[94:95], s[70:71] op_sel:[0,1] op_sel_hi:[1,1]
    v_lshlrev_b32 v80, 16, v20
    buffer_load_dwordx4 v10, s[20:23], s66 offen offset:3072 nt lds
    v_and_b32 v81, s72, v20
    v_lshlrev_b32 v82, 16, v21
    v_and_b32 v83, s72, v21
    v_lshlrev_b32 v84, 16, v22
    v_and_b32 v85, s72, v22
    v_lshlrev_b32 v86, 16, v23
    v_and_b32 v87, s72, v23
    v_pk_add_f32 v[120:121], v[120:121], v[80:81] neg_lo:[0,1] neg_hi:[0,1]
    v_pk_add_f32 v[122:123], v[122:123], v[82:83] neg_lo:[0,1] neg_hi:[0,1]
    v_pk_add_f32 v[124:125], v[124:125], v[84:85] neg_lo:[0,1] neg_hi:[0,1]
    v_pk_add_f32 v[126:127], v[126:127], v[86:87] neg_lo:[0,1] neg_hi:[0,1]
    v_cvt_pk_bf16_f32 v24, v120, v121
    v_cvt_pk_bf16_f32 v25, v122, v123
    v_cvt_pk_bf16_f32 v26, v124, v125
    tbuffer_load_format_d16_xyzw v[192:193], v167, s[28:31], 0 format:[BUF_DATA_FORMAT_32_32_32_32,BUF_NUM_FORMAT_UINT] offen nt
    v_cvt_pk_bf16_f32 v27, v126, v127
    ds_write_b128 v175, v[88:91]
    ds_write_b128 v175, v[92:95] offset:16
    ds_write2_b32 v176, v20, v22 offset0:64 offset1:65
    tbuffer_load_format_d16_xyzw v[194:195], v167, s[28:31], 0 format:[BUF_DATA_FORMAT_32_32_32_32,BUF_NUM_FORMAT_UINT] offen offset:1024 nt
    ds_write2_b32 v176, v21, v23 offset0:80 offset1:81
    ds_write2_b32 v176, v24, v26 offset0:96 offset1:97
    ds_write2_b32 v176, v25, v27 offset0:112 offset1:113
    s_waitcnt lgkmcnt(8)
    s_barrier
    v_mov_b32 v166, 106880
    ds_read_b128 v[64:67], v166
    s_mov_b32 s61, 0x0000b380
    s_waitcnt vmcnt(19)
    s_mov_b32 s62, 0xb3800000
    v_dot2_f32_bf16 v144, v104, s61, 0
    tbuffer_load_format_d16_xyzw v[196:197], v167, s[28:31], 0 format:[BUF_DATA_FORMAT_32_32_32_32,BUF_NUM_FORMAT_UINT] offen offset:2048 nt
    v_dot2_f32_bf16 v145, v104, s62, 0
    v_dot2_f32_bf16 v146, v105, s61, 0
    v_dot2_f32_bf16 v147, v105, s62, 0
    v_dot2_f32_bf16 v148, v106, s61, 0
    v_dot2_f32_bf16 v149, v106, s62, 0
    s_waitcnt vmcnt(19)
    v_dot2_f32_bf16 v150, v107, s61, 0
    v_dot2_f32_bf16 v151, v107, s62, 0
    v_dot2_f32_bf16 v152, v108, s61, 0
    v_dot2_f32_bf16 v153, v108, s62, 0
    v_dot2_f32_bf16 v154, v109, s61, 0
    v_dot2_f32_bf16 v155, v109, s62, 0
    v_dot2_f32_bf16 v156, v110, s61, 0
    v_dot2_f32_bf16 v157, v110, s62, 0
    s_waitcnt lgkmcnt(0)
    v_dot2_f32_bf16 v158, v111, s61, 0
    tbuffer_load_format_d16_xyzw v[198:199], v167, s[28:31], 0 format:[BUF_DATA_FORMAT_32_32_32_32,BUF_NUM_FORMAT_UINT] offen offset:3072 nt
    v_dot2_f32_bf16 v159, v111, s62, 0
    v_max3_f32 v165, v64, v65, v66
    v_max_f32 v66, v165, v67
    v_mul_f32 v165, 0x3e02b55b, v66
    s_nop 0
    v_readfirstlane_b32 s61, v165
    s_nop 0
    s_lshr_b32 s61, s61, 23
    s_max_u32 s61, s61, 20
    s_min_u32 s61, s61, 240
    s_lshl_b32 s62, s61, 23
    s_sub_u32 s70, 0x850293ee, s62
    s_add_u32 s61, s61, 9
    s_lshl_b32 s53, s61, 7
    s_lshl_b32 s54, s61, 23
    v_pk_mul_f32 v[128:129], v[128:129], s[70:71] op_sel_hi:[1,0]
    tbuffer_load_format_d16_xyzw v[200:201], v168, s[28:31], 0 format:[BUF_DATA_FORMAT_32_32_32_32,BUF_NUM_FORMAT_UINT] offen nt
    v_pk_mul_f32 v[130:131], v[130:131], s[70:71] op_sel_hi:[1,0]
    v_pk_mul_f32 v[132:133], v[132:133], s[70:71] op_sel_hi:[1,0]
    v_pk_mul_f32 v[134:135], v[134:135], s[70:71] op_sel_hi:[1,0]
    v_pk_mul_f32 v[136:137], v[136:137], s[70:71] op_sel_hi:[1,0]
    v_pk_mul_f32 v[138:139], v[138:139], s[70:71] op_sel_hi:[1,0]
    v_pk_mul_f32 v[140:141], v[140:141], s[70:71] op_sel_hi:[1,0]
    v_pk_mul_f32 v[142:143], v[142:143], s[70:71] op_sel_hi:[1,0]
    v_pk_mul_f32 v[144:145], v[144:145], v[128:129]
    v_pk_mul_f32 v[146:147], v[146:147], v[130:131]
    v_pk_mul_f32 v[148:149], v[148:149], v[132:133]
    v_pk_mul_f32 v[150:151], v[150:151], v[134:135]
    v_pk_mul_f32 v[152:153], v[152:153], v[136:137]
    v_pk_mul_f32 v[154:155], v[154:155], v[138:139]
    v_pk_mul_f32 v[156:157], v[156:157], v[140:141]
    tbuffer_load_format_d16_xyzw v[202:203], v168, s[28:31], 0 format:[BUF_DATA_FORMAT_32_32_32_32,BUF_NUM_FORMAT_UINT] offen offset:1024 nt
    v_pk_mul_f32 v[158:159], v[158:159], v[142:143]
    v_min3_f32 v64, abs(v128), abs(v129), abs(v130)
    v_min3_f32 v64, v64, abs(v131), abs(v132)
    v_min3_f32 v64, v64, abs(v133), abs(v134)
    v_min3_f32 v64, v64, abs(v135), abs(v136)
    v_min3_f32 v64, v64, abs(v137), abs(v138)
    v_min3_f32 v64, v64, abs(v139), abs(v140)
    v_min3_f32 v64, v64, abs(v141), abs(v142)
    v_min_f32_e64 v64, v64, abs(v143)
    v_mul_f32 v65, s70, v66
    v_max3_f32 v65, v65, abs(v144), abs(v145)
    v_max3_f32 v65, v65, abs(v146), abs(v147)
    v_max3_f32 v65, v65, abs(v148), abs(v149)
    v_max3_f32 v65, v65, abs(v150), abs(v151)
    tbuffer_load_format_d16_xyzw v[204:205], v168, s[28:31], 0 format:[BUF_DATA_FORMAT_32_32_32_32,BUF_NUM_FORMAT_UINT] offen offset:2048 nt
    v_max3_f32 v65, v65, abs(v152), abs(v153)
    v_max3_f32 v65, v65, abs(v154), abs(v155)
    v_max3_f32 v65, v65, abs(v156), abs(v157)
    v_max3_f32 v65, v65, abs(v158), abs(v159)
    v_mov_b32 v166, 0x7fc00000
    v_cmp_le_f32 vcc, 0x43000000, v64
    s_nop 1
    v_cndmask_b32 v144, v166, v144, vcc
    v_cmp_ge_f32 vcc, 0x477fdc00, v65
    s_nop 1
    v_cndmask_b32 v144, v166, v144, vcc
    v_cvt_pk_f16_f32 v68, v128, v129
    v_cvt_pk_f16_f32 v69, v130, v131
    v_cvt_pk_f16_f32 v70, v144, v145
    v_cvt_pk_f16_f32 v71, v146, v147
    ds_write_b128 v174, v[68:71]
    tbuffer_load_format_d16_xyzw v[206:207], v168, s[28:31], 0 format:[BUF_DATA_FORMAT_32_32_32_32,BUF_NUM_FORMAT_UINT] offen offset:3072 nt
    v_cvt_pk_f16_f32 v72, v132, v133
    v_cvt_pk_f16_f32 v73, v134, v135
    v_cvt_pk_f16_f32 v74, v148, v149
    v_cvt_pk_f16_f32 v75, v150, v151
    ds_write_b128 v174, v[72:75] offset:16
    v_cvt_pk_f16_f32 v68, v136, v137
    v_cvt_pk_f16_f32 v69, v138, v139
    v_cvt_pk_f16_f32 v70, v152, v153
    v_cvt_pk_f16_f32 v71, v154, v155
    ds_write_b128 v174, v[68:71] offset:8192
    s_add_u32 m0, s64, 8192
    s_nop 0
    buffer_load_dwordx4 v9, s[20:23], s65 offen nt lds
    v_cvt_pk_f16_f32 v72, v140, v141
    v_cvt_pk_f16_f32 v73, v142, v143
    v_cvt_pk_f16_f32 v74, v156, v157
    v_cvt_pk_f16_f32 v75, v158, v159
    ds_write_b128 v174, v[72:75] offset:8208
    s_waitcnt lgkmcnt(0)
    s_barrier
    ds_read_b128 v[20:23], v8
    ds_read_b128 v[12:15], v5
    ds_read_b128 v[16:19], v5 offset:16
    s_waitcnt vmcnt(20) lgkmcnt(2)
    ds_read_b128 v[180:183], v5 offset:128
    buffer_load_dwordx4 v10, s[20:23], s65 offen offset:1024 nt lds
    ds_read_b128 v[184:187], v5 offset:144
    v_pk_fma_f16 v224, v224, v20, v22
    s_waitcnt vmcnt(19)
    v_pk_fma_f16 v225, v225, v21, v23
    v_pk_fma_f16 v226, v226, v20, v22
    v_pk_fma_f16 v227, v227, v21, v23
    v_pk_fma_f16 v228, v228, v20, v22
    s_waitcnt vmcnt(17)
    v_pk_fma_f16 v229, v229, v21, v23
    v_pk_fma_f16 v230, v230, v20, v22
    v_pk_fma_f16 v231, v231, v21, v23
    v_pk_fma_f16 v232, v232, v20, v22
    s_waitcnt vmcnt(15)
    v_pk_fma_f16 v233, v233, v21, v23
    v_pk_fma_f16 v234, v234, v20, v22
    v_pk_fma_f16 v235, v235, v21, v23
    v_pk_fma_f16 v236, v236, v20, v22
    s_waitcnt vmcnt(14)
    buffer_load_dwordx4 v9, s[20:23], s65 offen offset:2048 nt lds
    v_pk_fma_f16 v237, v237, v21, v23
    v_pk_fma_f16 v238, v238, v20, v22
    v_pk_fma_f16 v239, v239, v21, v23
    ds_read_b128 v[20:23], v8 offset:512
    s_mov_b32 m0, s52
    s_nop 0
    ds_write_addtid_b32 v224
    ds_write_addtid_b32 v225 offset:256
    ds_write_addtid_b32 v226 offset:4112
    ds_write_addtid_b32 v227 offset:4368
    ds_write_addtid_b32 v228 offset:512
    ds_write_addtid_b32 v229 offset:768
    ds_write_addtid_b32 v230 offset:4624
    ds_write_addtid_b32 v231 offset:4880
    ds_write_addtid_b32 v232 offset:8224
    ds_write_addtid_b32 v233 offset:8480
    s_waitcnt lgkmcnt(14)
    s_add_u32 m0, s64, 8192
    s_nop 0
    buffer_load_dwordx4 v10, s[20:23], s65 offen offset:3072 nt lds
    s_mov_b32 m0, s52
    s_nop 0
    ds_write_addtid_b32 v234 offset:12336
    s_waitcnt lgkmcnt(11)
    ds_write_addtid_b32 v235 offset:12592
    ds_write_addtid_b32 v236 offset:8736
    ds_write_addtid_b32 v237 offset:8992
    ds_write_addtid_b32 v238 offset:12848
    s_waitcnt lgkmcnt(11)
    ds_write_addtid_b32 v239 offset:13104
    ds_read_b128 v[96:99], v170
    ds_read_b128 v[100:103], v171
    ds_read_b128 v[128:131], v172
    s_waitcnt lgkmcnt(14)
    ds_read_b128 v[132:135], v173
    s_waitcnt lgkmcnt(4)
    s_barrier
    ds_read_b128 a[148:151], v3
    ds_read_b128 a[152:155], v3 offset:512
    ds_read_b128 a[156:159], v3 offset:1024
    s_add_u32 s28, s28, 16384
    s_addc_u32 s29, s29, 0
    s_sub_u32 s30, s30, 16384
    s_max_i32 s30, s30, 0
    tbuffer_load_format_d16_xyzw v[48:49], v1, s[28:31], 0 format:[BUF_DATA_FORMAT_32_32_32_32,BUF_NUM_FORMAT_UINT] offen nt
    ds_read_b128 a[160:163], v3 offset:1536
    ds_read_b128 a[164:167], v3 offset:256
    ds_read_b128 a[168:171], v3 offset:768
    ds_read_b128 a[172:175], v3 offset:1280
    ds_read_b128 a[176:179], v3 offset:1792
    ds_read_b128 a[180:183], v3 offset:16
    ds_read_b128 a[184:187], v3 offset:528
    s_waitcnt lgkmcnt(11)
    ds_read_b128 a[188:191], v3 offset:1040
    ds_read_b128 a[192:195], v3 offset:1552
    ds_read_b128 a[196:199], v3 offset:272
    ds_read_b128 a[200:203], v3 offset:784
    s_waitcnt lgkmcnt(13)
    ds_read_b128 a[204:207], v3 offset:1296
    ds_read_b128 a[208:211], v3 offset:1808
    v_dot2_f32_bf16 v64, v96, s53, 0
    tbuffer_load_format_d16_xyzw v[50:51], v1, s[28:31], 0 format:[BUF_DATA_FORMAT_32_32_32_32,BUF_NUM_FORMAT_UINT] offen offset:1024 nt
    v_dot2_f32_bf16 v65, v96, s54, 0
    v_dot2_f32_bf16 v66, v97, s53, 0
    v_dot2_f32_bf16 v67, v97, s54, 0
    v_dot2_f32_bf16 v68, v98, s53, 0
    v_dot2_f32_bf16 v69, v98, s54, 0
    v_dot2_f32_bf16 v70, v99, s53, 0
    v_dot2_f32_bf16 v71, v99, s54, 0
    v_cvt_pk_f16_f32 v96, v64, v65
    v_cvt_pk_f16_f32 v97, v66, v67
    v_cvt_pk_f16_f32 v98, v68, v69
    v_cvt_pk_f16_f32 v99, v70, v71
    v_accvgpr_write_b32 a96, v96
    v_accvgpr_write_b32 a100, v97
    v_accvgpr_write_b32 a97, v98
    tbuffer_load_format_d16_xyzw v[52:53], v1, s[28:31], 0 format:[BUF_DATA_FORMAT_32_32_32_32,BUF_NUM_FORMAT_UINT] offen offset:2048 nt
    v_accvgpr_write_b32 a101, v99
    v_dot2_f32_bf16 v64, v100, s53, 0
    v_dot2_f32_bf16 v65, v100, s54, 0
    v_dot2_f32_bf16 v66, v101, s53, 0
    v_dot2_f32_bf16 v67, v101, s54, 0
    v_dot2_f32_bf16 v68, v102, s53, 0
    v_dot2_f32_bf16 v69, v102, s54, 0
    v_dot2_f32_bf16 v70, v103, s53, 0
    v_dot2_f32_bf16 v71, v103, s54, 0
    v_cvt_pk_f16_f32 v100, v64, v65
    v_cvt_pk_f16_f32 v101, v66, v67
    v_cvt_pk_f16_f32 v102, v68, v69
    v_cvt_pk_f16_f32 v103, v70, v71
    v_accvgpr_write_b32 a98, v100
    tbuffer_load_format_d16_xyzw v[54:55], v1, s[28:31], 0 format:[BUF_DATA_FORMAT_32_32_32_32,BUF_NUM_FORMAT_UINT] offen offset:3072 nt
    v_accvgpr_write_b32 a102, v101
    v_accvgpr_write_b32 a99, v102
    v_accvgpr_write_b32 a103, v103
    v_dot2_f32_bf16 v64, v128, s53, 0
    v_dot2_f32_bf16 v65, v128, s54, 0
    v_dot2_f32_bf16 v66, v129, s53, 0
    v_dot2_f32_bf16 v67, v129, s54, 0
    v_dot2_f32_bf16 v68, v130, s53, 0
    v_dot2_f32_bf16 v69, v130, s54, 0
    v_dot2_f32_bf16 v70, v131, s53, 0
    v_dot2_f32_bf16 v71, v131, s54, 0
    v_cvt_pk_f16_f32 v128, v64, v65
    v_cvt_pk_f16_f32 v129, v66, v67
    v_cvt_pk_f16_f32 v130, v68, v69
    tbuffer_load_format_d16_xyzw v[56:57], v2, s[28:31], 0 format:[BUF_DATA_FORMAT_32_32_32_32,BUF_NUM_FORMAT_UINT] offen nt
    v_cvt_pk_f16_f32 v131, v70, v71
    v_accvgpr_write_b32 a104, v128
    v_accvgpr_write_b32 a108, v129
    v_accvgpr_write_b32 a105, v130
    v_accvgpr_write_b32 a109, v131
    v_dot2_f32_bf16 v64, v132, s53, 0
    v_dot2_f32_bf16 v65, v132, s54, 0
    v_dot2_f32_bf16 v66, v133, s53, 0
    v_dot2_f32_bf16 v67, v133, s54, 0
    v_dot2_f32_bf16 v68, v134, s53, 0
    v_dot2_f32_bf16 v69, v134, s54, 0
    v_dot2_f32_bf16 v70, v135, s53, 0
    v_dot2_f32_bf16 v71, v135, s54, 0
    v_cvt_pk_f16_f32 v132, v64, v65
    tbuffer_load_format_d16_xyzw v[58:59], v2, s[28:31], 0 format:[BUF_DATA_FORMAT_32_32_32_32,BUF_NUM_FORMAT_UINT] offen offset:1024 nt
    v_cvt_pk_f16_f32 v133, v66, v67
    v_cvt_pk_f16_f32 v134, v68, v69
    v_cvt_pk_f16_f32 v135, v70, v71
    v_accvgpr_write_b32 a106, v132
    s_waitcnt vmcnt(18) lgkmcnt(14)
    v_accvgpr_write_b32 a110, v133
    v_accvgpr_write_b32 a107, v134
    v_accvgpr_write_b32 a111, v135
    ds_read_b128 v[96:99], v170 offset:4096
    s_waitcnt lgkmcnt(12)
    ds_read_b128 v[100:103], v171 offset:4096
    ds_read_b128 v[128:131], v172 offset:4096
    ds_read_b128 v[132:135], v173 offset:4096
    v_mfma_f32_16x16x32_f16 v[120:123], a[148:151], a[96:99], v[12:15]
    s_waitcnt vmcnt(17) lgkmcnt(13)
    ds_write_addtid_b32 v192 offset:32896
    tbuffer_load_format_d16_xyzw v[60:61], v2, s[28:31], 0 format:[BUF_DATA_FORMAT_32_32_32_32,BUF_NUM_FORMAT_UINT] offen offset:2048 nt
    ds_write_addtid_b32 v193 offset:33152
    v_mfma_f32_16x16x32_f16 v[124:127], a[152:155], a[96:99], v[16:19]
    s_waitcnt vmcnt(17) lgkmcnt(13)
    ds_write_addtid_b32 v194 offset:37024
    ds_write_addtid_b32 v195 offset:37280
    v_mfma_f32_16x16x32_f16 v[152:155], a[156:159], a[96:99], v[180:183]
    s_waitcnt vmcnt(16) lgkmcnt(13)
    ds_write_addtid_b32 v196 offset:33408
    ds_write_addtid_b32 v197 offset:33664
    v_mfma_f32_16x16x32_f16 v[156:159], a[160:163], a[96:99], v[184:187]
    s_waitcnt vmcnt(15) lgkmcnt(13)
    ds_write_addtid_b32 v198 offset:37536
    ds_write_addtid_b32 v199 offset:37792
    v_mfma_f32_16x16x32_f16 v[120:123], a[164:167], a[100:103], v[120:123]
    tbuffer_load_format_d16_xyzw v[62:63], v2, s[28:31], 0 format:[BUF_DATA_FORMAT_32_32_32_32,BUF_NUM_FORMAT_UINT] offen offset:3072 nt
    s_add_u32 s28, s28, 32768
    s_addc_u32 s29, s29, 0
    s_sub_u32 s30, s30, 32768
    s_waitcnt vmcnt(15) lgkmcnt(13)
    s_max_i32 s30, s30, 0
    ds_write_addtid_b32 v200 offset:41152
    ds_write_addtid_b32 v201 offset:41408
    v_mfma_f32_16x16x32_f16 v[124:127], a[168:171], a[100:103], v[124:127]
    s_waitcnt vmcnt(14) lgkmcnt(13)
    ds_write_addtid_b32 v202 offset:45280
    ds_write_addtid_b32 v203 offset:45536
    v_mfma_f32_16x16x32_f16 v[152:155], a[172:175], a[100:103], v[152:155]
    s_waitcnt vmcnt(13) lgkmcnt(13)
    ds_write_addtid_b32 v204 offset:41664
    ds_write_addtid_b32 v205 offset:41920
    v_mfma_f32_16x16x32_f16 v[156:159], a[176:179], a[100:103], v[156:159]
    s_waitcnt vmcnt(12) lgkmcnt(13)
    ds_write_addtid_b32 v206 offset:45792
    ds_write_addtid_b32 v207 offset:46048
    s_add_u32 m0, s64, 0
    s_nop 0
    buffer_load_dwordx4 v9, s[20:23], s56 offen nt lds
    v_mfma_f32_16x16x32_f16 v[120:123], a[180:183], a[104:107], v[120:123]
    v_mfma_f32_16x16x32_f16 v[124:127], a[184:187], a[104:107], v[124:127]
    v_mfma_f32_16x16x32_f16 v[152:155], a[188:191], a[104:107], v[152:155]
    v_mfma_f32_16x16x32_f16 v[156:159], a[192:195], a[104:107], v[156:159]
    v_mfma_f32_16x16x32_f16 v[120:123], a[196:199], a[108:111], v[120:123]
    v_mfma_f32_16x16x32_f16 v[124:127], a[200:203], a[108:111], v[124:127]
    v_mfma_f32_16x16x32_f16 v[152:155], a[204:207], a[108:111], v[152:155]
    buffer_load_dwordx4 v10, s[20:23], s56 offen offset:1024 nt lds
    v_mfma_f32_16x16x32_f16 v[156:159], a[208:211], a[108:111], v[156:159]
    v_dot2_f32_bf16 v64, v96, s53, 0
    v_dot2_f32_bf16 v65, v96, s54, 0
    v_dot2_f32_bf16 v66, v97, s53, 0
    v_dot2_f32_bf16 v67, v97, s54, 0
    v_dot2_f32_bf16 v68, v98, s53, 0
    v_dot2_f32_bf16 v69, v98, s54, 0
    v_dot2_f32_bf16 v70, v99, s53, 0
    v_dot2_f32_bf16 v71, v99, s54, 0
    v_cvt_pk_f16_f32 v96, v64, v65
    v_cvt_pk_f16_f32 v97, v66, v67
    v_cvt_pk_f16_f32 v98, v68, v69
    v_cvt_pk_f16_f32 v99, v70, v71
    buffer_load_dwordx4 v9, s[20:23], s56 offen offset:2048 nt lds
    v_accvgpr_write_b32 a80, v96
    v_accvgpr_write_b32 a84, v97
    v_accvgpr_write_b32 a81, v98
    v_accvgpr_write_b32 a85, v99
    v_dot2_f32_bf16 v64, v100, s53, 0
    v_dot2_f32_bf16 v65, v100, s54, 0
    v_dot2_f32_bf16 v66, v101, s53, 0
    v_dot2_f32_bf16 v67, v101, s54, 0
    v_dot2_f32_bf16 v68, v102, s53, 0
    v_dot2_f32_bf16 v69, v102, s54, 0
    v_dot2_f32_bf16 v70, v103, s53, 0
    v_dot2_f32_bf16 v71, v103, s54, 0
    v_cvt_pk_f16_f32 v100, v64, v65
    v_cvt_pk_f16_f32 v101, v66, v67
    buffer_load_dwordx4 v10, s[20:23], s56 offen offset:3072 nt lds
    v_cvt_pk_f16_f32 v102, v68, v69
    v_cvt_pk_f16_f32 v103, v70, v71
    v_accvgpr_write_b32 a82, v100
    v_accvgpr_write_b32 a86, v101
    v_accvgpr_write_b32 a83, v102
    v_accvgpr_write_b32 a87, v103
    v_dot2_f32_bf16 v64, v128, s53, 0
    v_dot2_f32_bf16 v65, v128, s54, 0
    v_dot2_f32_bf16 v66, v129, s53, 0
    v_dot2_f32_bf16 v67, v129, s54, 0
    v_dot2_f32_bf16 v68, v130, s53, 0
    v_dot2_f32_bf16 v69, v130, s54, 0
    v_dot2_f32_bf16 v70, v131, s53, 0
    v_dot2_f32_bf16 v71, v131, s54, 0
    s_add_u32 s24, s24, 32768
    s_addc_u32 s25, s25, 0
    s_sub_u32 s26, s26, 32768
    s_max_i32 s26, s26, 0
    tbuffer_load_format_d16_xyzw v[32:33], v1, s[24:27], 0 format:[BUF_DATA_FORMAT_32_32_32_32,BUF_NUM_FORMAT_UINT] offen nt
    v_cvt_pk_f16_f32 v128, v64, v65
    v_cvt_pk_f16_f32 v129, v66, v67
    v_cvt_pk_f16_f32 v130, v68, v69
    v_cvt_pk_f16_f32 v131, v70, v71
    v_accvgpr_write_b32 a88, v128
    v_accvgpr_write_b32 a92, v129
    v_accvgpr_write_b32 a89, v130
    v_accvgpr_write_b32 a93, v131
    v_dot2_f32_bf16 v64, v132, s53, 0
    v_dot2_f32_bf16 v65, v132, s54, 0
    v_dot2_f32_bf16 v66, v133, s53, 0
    v_dot2_f32_bf16 v67, v133, s54, 0
    v_dot2_f32_bf16 v68, v134, s53, 0
    v_dot2_f32_bf16 v69, v134, s54, 0
    tbuffer_load_format_d16_xyzw v[34:35], v1, s[24:27], 0 format:[BUF_DATA_FORMAT_32_32_32_32,BUF_NUM_FORMAT_UINT] offen offset:1024 nt
    v_dot2_f32_bf16 v70, v135, s53, 0
    v_dot2_f32_bf16 v71, v135, s54, 0
    v_cvt_pk_f16_f32 v132, v64, v65
    v_cvt_pk_f16_f32 v133, v66, v67
    v_cvt_pk_f16_f32 v134, v68, v69
    v_cvt_pk_f16_f32 v135, v70, v71
    v_accvgpr_write_b32 a90, v132
    v_accvgpr_write_b32 a94, v133
    v_accvgpr_write_b32 a91, v134
    v_accvgpr_write_b32 a95, v135
    s_waitcnt lgkmcnt(0)
    s_barrier
    ds_read_b64_tr_b16 a[112:113], v4 offset:1024
    ds_read_b64_tr_b16 a[114:115], v4 offset:1536
    ds_read_b64_tr_b16 a[116:117], v4 offset:1280
    tbuffer_load_format_d16_xyzw v[36:37], v1, s[24:27], 0 format:[BUF_DATA_FORMAT_32_32_32_32,BUF_NUM_FORMAT_UINT] offen offset:2048 nt
    ds_read_b64_tr_b16 a[118:119], v4 offset:1792
    ds_read_b64_tr_b16 a[120:121], v4 offset:1056
    ds_read_b64_tr_b16 a[122:123], v4 offset:1568
    ds_read_b64_tr_b16 a[124:125], v4 offset:1312
    ds_read_b64_tr_b16 a[126:127], v4 offset:1824
    ds_read_b64_tr_b16 a[128:129], v4 offset:1088
    ds_read_b64_tr_b16 a[130:131], v4 offset:1600
    ds_read_b64_tr_b16 a[132:133], v4 offset:1344
    ds_read_b64_tr_b16 a[134:135], v4 offset:1856
    ds_read_b64_tr_b16 a[136:137], v4 offset:1120
    ds_read_b64_tr_b16 a[138:139], v4 offset:1632
    s_waitcnt vmcnt(15) lgkmcnt(12)
    ds_read_b64_tr_b16 a[140:141], v4 offset:1376
    ds_read_b64_tr_b16 a[142:143], v4 offset:1888
    ds_read_b128 v[96:99], v170 offset:8192
    tbuffer_load_format_d16_xyzw v[38:39], v1, s[24:27], 0 format:[BUF_DATA_FORMAT_32_32_32_32,BUF_NUM_FORMAT_UINT] offen offset:3072 nt
    s_waitcnt lgkmcnt(12)
    ds_read_b128 v[100:103], v171 offset:8192
    ds_read_b128 v[128:131], v172 offset:8192
    ds_read_b128 v[132:135], v173 offset:8192
    v_mfma_f32_16x16x32_f16 v[112:115], a[148:151], a[80:83], v[12:15]
    v_exp_f32 v120, v120
    v_mfma_f32_16x16x32_f16 v[116:119], a[152:155], a[80:83], v[16:19]
    v_exp_f32 v121, v121
    v_mfma_f32_16x16x32_f16 v[144:147], a[156:159], a[80:83], v[180:183]
    v_exp_f32 v122, v122
    tbuffer_load_format_d16_xyzw v[40:41], v2, s[24:27], 0 format:[BUF_DATA_FORMAT_32_32_32_32,BUF_NUM_FORMAT_UINT] offen nt
    v_mfma_f32_16x16x32_f16 v[148:151], a[160:163], a[80:83], v[184:187]
    v_exp_f32 v123, v123
    v_mfma_f32_16x16x32_f16 v[112:115], a[164:167], a[84:87], v[112:115]
    v_cvt_pk_bf16_f32 v88, v120, v121
    v_exp_f32 v124, v124
    v_mfma_f32_16x16x32_f16 v[116:119], a[168:171], a[84:87], v[116:119]
    v_exp_f32 v125, v125
    v_mfma_f32_16x16x32_f16 v[144:147], a[172:175], a[84:87], v[144:147]
    tbuffer_load_format_d16_xyzw v[42:43], v2, s[24:27], 0 format:[BUF_DATA_FORMAT_32_32_32_32,BUF_NUM_FORMAT_UINT] offen offset:1024 nt
    v_cvt_pk_bf16_f32 v89, v122, v123
    v_exp_f32 v126, v126
    v_mfma_f32_16x16x32_f16 v[148:151], a[176:179], a[84:87], v[148:151]
    v_exp_f32 v127, v127
    v_mfma_f32_16x16x32_f16 v[112:115], a[180:183], a[88:91], v[112:115]
    v_cvt_pk_bf16_f32 v90, v124, v125
    v_cvt_pk_bf16_f32 v91, v126, v127
    v_mfma_f32_16x16x32_f16 v[116:119], a[184:187], a[88:91], v[116:119]
    v_exp_f32 v152, v152
    tbuffer_load_format_d16_xyzw v[44:45], v2, s[24:27], 0 format:[BUF_DATA_FORMAT_32_32_32_32,BUF_NUM_FORMAT_UINT] offen offset:2048 nt
    v_mfma_f32_16x16x32_f16 v[144:147], a[188:191], a[88:91], v[144:147]
    v_exp_f32 v153, v153
    v_mfma_f32_16x16x32_f16 v[148:151], a[192:195], a[88:91], v[148:151]
    v_exp_f32 v154, v154
    v_mfma_f32_16x16x32_f16 v[112:115], a[196:199], a[92:95], v[112:115]
    v_exp_f32 v155, v155
    v_mfma_f32_16x16x32_f16 v[116:119], a[200:203], a[92:95], v[116:119]
    tbuffer_load_format_d16_xyzw v[46:47], v2, s[24:27], 0 format:[BUF_DATA_FORMAT_32_32_32_32,BUF_NUM_FORMAT_UINT] offen offset:3072 nt
    s_add_u32 s24, s24, 32768
    s_addc_u32 s25, s25, 0
    s_sub_u32 s26, s26, 32768
    s_max_i32 s26, s26, 0
    v_cvt_pk_bf16_f32 v92, v152, v153
    v_exp_f32 v156, v156
    v_mfma_f32_16x16x32_f16 v[144:147], a[204:207], a[92:95], v[144:147]
    v_exp_f32 v157, v157
    v_mfma_f32_16x16x32_f16 v[148:151], a[208:211], a[92:95], v[148:151]
    v_cvt_pk_bf16_f32 v93, v154, v155
    v_exp_f32 v158, v158
    v_exp_f32 v159, v159
    v_cvt_pk_bf16_f32 v94, v156, v157
    s_waitcnt lgkmcnt(3)
    v_cvt_pk_bf16_f32 v95, v158, v159
    v_dot2_f32_bf16 v64, v96, s53, 0
    v_dot2_f32_bf16 v65, v96, s54, 0
    v_dot2_f32_bf16 v66, v97, s53, 0
    v_dot2_f32_bf16 v67, v97, s54, 0
    v_dot2_f32_bf16 v68, v98, s53, 0
    v_dot2_f32_bf16 v69, v98, s54, 0
    v_dot2_f32_bf16 v70, v99, s53, 0
    v_dot2_f32_bf16 v71, v99, s54, 0
    v_cvt_pk_f16_f32 v96, v64, v65
    v_cvt_pk_f16_f32 v97, v66, v67
    v_cvt_pk_f16_f32 v98, v68, v69
    v_cvt_pk_f16_f32 v99, v70, v71
    v_accvgpr_write_b32 a64, v96
    v_accvgpr_write_b32 a68, v97
    v_accvgpr_write_b32 a65, v98
    s_waitcnt lgkmcnt(2)
    v_accvgpr_write_b32 a69, v99
    v_dot2_f32_bf16 v64, v100, s53, 0
    v_dot2_f32_bf16 v65, v100, s54, 0
    v_dot2_f32_bf16 v66, v101, s53, 0
    v_dot2_f32_bf16 v67, v101, s54, 0
    v_dot2_f32_bf16 v68, v102, s53, 0
    v_dot2_f32_bf16 v69, v102, s54, 0
    v_dot2_f32_bf16 v70, v103, s53, 0
    v_dot2_f32_bf16 v71, v103, s54, 0
    v_cvt_pk_f16_f32 v100, v64, v65
    v_cvt_pk_f16_f32 v101, v66, v67
    v_cvt_pk_f16_f32 v102, v68, v69
    v_cvt_pk_f16_f32 v103, v70, v71
    v_accvgpr_write_b32 a66, v100
    v_accvgpr_write_b32 a70, v101
    v_accvgpr_write_b32 a67, v102
    s_waitcnt lgkmcnt(1)
    v_accvgpr_write_b32 a71, v103
    v_dot2_f32_bf16 v64, v128, s53, 0
    v_dot2_f32_bf16 v65, v128, s54, 0
    v_dot2_f32_bf16 v66, v129, s53, 0
    v_dot2_f32_bf16 v67, v129, s54, 0
    v_dot2_f32_bf16 v68, v130, s53, 0
    v_dot2_f32_bf16 v69, v130, s54, 0
    v_dot2_f32_bf16 v70, v131, s53, 0
    v_dot2_f32_bf16 v71, v131, s54, 0
    v_cvt_pk_f16_f32 v128, v64, v65
    v_cvt_pk_f16_f32 v129, v66, v67
    v_cvt_pk_f16_f32 v130, v68, v69
    v_cvt_pk_f16_f32 v131, v70, v71
    v_accvgpr_write_b32 a72, v128
    v_accvgpr_write_b32 a76, v129
    v_accvgpr_write_b32 a73, v130
    s_waitcnt lgkmcnt(0)
    v_accvgpr_write_b32 a77, v131
    v_dot2_f32_bf16 v64, v132, s53, 0
    v_dot2_f32_bf16 v65, v132, s54, 0
    v_dot2_f32_bf16 v66, v133, s53, 0
    v_dot2_f32_bf16 v67, v133, s54, 0
    v_dot2_f32_bf16 v68, v134, s53, 0
    v_dot2_f32_bf16 v69, v134, s54, 0
    v_dot2_f32_bf16 v70, v135, s53, 0
    v_dot2_f32_bf16 v71, v135, s54, 0
    v_cvt_pk_f16_f32 v132, v64, v65
    v_cvt_pk_f16_f32 v133, v66, v67
    v_cvt_pk_f16_f32 v134, v68, v69
    v_cvt_pk_f16_f32 v135, v70, v71
    v_accvgpr_write_b32 a74, v132
    v_accvgpr_write_b32 a78, v133
    v_accvgpr_write_b32 a75, v134
    v_accvgpr_write_b32 a79, v135
    v_mfma_f32_16x16x32_f16 v[104:107], a[148:151], a[64:67], v[12:15]
    v_exp_f32 v112, v112
    v_mfma_f32_16x16x32_f16 v[108:111], a[152:155], a[64:67], v[16:19]
    v_exp_f32 v113, v113
    v_mfma_f32_16x16x32_f16 v[136:139], a[156:159], a[64:67], v[180:183]
    v_exp_f32 v114, v114
    v_mfma_f32_16x16x32_f16 v[140:143], a[160:163], a[64:67], v[184:187]
    v_exp_f32 v115, v115
    v_mfma_f32_16x16x32_f16 v[104:107], a[164:167], a[68:71], v[104:107]
    v_cvt_pk_bf16_f32 v80, v112, v113
    v_exp_f32 v116, v116
    v_mfma_f32_16x16x32_f16 v[108:111], a[168:171], a[68:71], v[108:111]
    v_exp_f32 v117, v117
    v_mfma_f32_16x16x32_f16 v[136:139], a[172:175], a[68:71], v[136:139]
    v_cvt_pk_bf16_f32 v81, v114, v115
    v_exp_f32 v118, v118
    v_mfma_f32_16x16x32_f16 v[140:143], a[176:179], a[68:71], v[140:143]
    v_exp_f32 v119, v119
    v_mfma_f32_16x16x32_f16 v[104:107], a[180:183], a[72:75], v[104:107]
    v_cvt_pk_bf16_f32 v82, v116, v117
    v_cvt_pk_bf16_f32 v83, v118, v119
    v_mfma_f32_16x16x32_f16 v[108:111], a[184:187], a[72:75], v[108:111]
    v_exp_f32 v144, v144
    v_mfma_f32_16x16x32_f16 v[136:139], a[188:191], a[72:75], v[136:139]
    v_exp_f32 v145, v145
    v_mfma_f32_16x16x32_f16 v[140:143], a[192:195], a[72:75], v[140:143]
    s_waitcnt vmcnt(19)
    v_cvt_pk_bf16_f32 v84, v144, v145
    s_mov_b32 m0, s52
    s_nop 0
    ds_write_addtid_b32 v48 offset:49408
    v_mfma_f32_16x16x32_f16 v[104:107], a[196:199], a[76:79], v[104:107]
    s_waitcnt vmcnt(18)
    ds_write_addtid_b32 v49 offset:49664
    ds_write_addtid_b32 v50 offset:53536
    v_mfma_f32_16x16x32_f16 v[108:111], a[200:203], a[76:79], v[108:111]
    s_waitcnt vmcnt(17)
    ds_write_addtid_b32 v51 offset:53792
    ds_write_addtid_b32 v52 offset:49920
    v_mfma_f32_16x16x32_f16 v[136:139], a[204:207], a[76:79], v[136:139]
    s_waitcnt vmcnt(16)
    ds_write_addtid_b32 v53 offset:50176
    ds_write_addtid_b32 v54 offset:54048
    v_mfma_f32_16x16x32_f16 v[140:143], a[208:211], a[76:79], v[140:143]
    s_waitcnt vmcnt(14)
    ds_write_addtid_b32 v55 offset:54304
    ds_write_addtid_b32 v56 offset:57664
    ds_write_addtid_b32 v57 offset:57920
    ds_write_addtid_b32 v58 offset:61792
    s_waitcnt vmcnt(12)
    ds_write_addtid_b32 v59 offset:62048
    ds_write_addtid_b32 v60 offset:58176
    ds_write_addtid_b32 v61 offset:58432
    ds_write_addtid_b32 v62 offset:62304
    s_waitcnt vmcnt(8) lgkmcnt(12)
    ds_write_addtid_b32 v63 offset:62560
    tbuffer_load_format_d16_xyzw v[48:49], v1, s[28:31], 0 format:[BUF_DATA_FORMAT_32_32_32_32,BUF_NUM_FORMAT_UINT] offen nt
    ds_read_b128 v[96:99], v170
    ds_read_b128 v[100:103], v171
    s_waitcnt lgkmcnt(13)
    ds_read_b128 v[128:131], v172
    ds_read_b128 v[132:135], v173
    v_mfma_f32_16x16x32_bf16 v[224:227], a[112:115], v[88:91], 0
    v_exp_f32 v104, v104
    v_mfma_f32_16x16x32_bf16 v[228:231], a[116:119], v[88:91], 0
    v_exp_f32 v105, v105
    v_mfma_f32_16x16x32_bf16 v[232:235], a[120:123], v[88:91], 0
    tbuffer_load_format_d16_xyzw v[50:51], v1, s[28:31], 0 format:[BUF_DATA_FORMAT_32_32_32_32,BUF_NUM_FORMAT_UINT] offen offset:1024 nt
    v_exp_f32 v106, v106
    v_mfma_f32_16x16x32_bf16 v[236:239], a[124:127], v[88:91], 0
    v_exp_f32 v107, v107
    v_mfma_f32_16x16x32_bf16 v[240:243], a[128:131], v[88:91], 0
    v_cvt_pk_bf16_f32 v72, v104, v105
    v_exp_f32 v108, v108
    v_mfma_f32_16x16x32_bf16 v[192:195], a[112:115], v[80:83], 0
    v_exp_f32 v109, v109
    tbuffer_load_format_d16_xyzw v[52:53], v1, s[28:31], 0 format:[BUF_DATA_FORMAT_32_32_32_32,BUF_NUM_FORMAT_UINT] offen offset:2048 nt
    v_mfma_f32_16x16x32_bf16 v[196:199], a[116:119], v[80:83], 0
    v_cvt_pk_bf16_f32 v73, v106, v107
    v_exp_f32 v110, v110
    v_mfma_f32_16x16x32_bf16 v[200:203], a[120:123], v[80:83], 0
    v_exp_f32 v111, v111
    v_mfma_f32_16x16x32_bf16 v[204:207], a[124:127], v[80:83], 0
    v_cvt_pk_bf16_f32 v74, v108, v109
    v_cvt_pk_bf16_f32 v75, v110, v111
    v_mfma_f32_16x16x32_bf16 v[208:211], a[128:131], v[80:83], 0
    s_waitcnt lgkmcnt(3)
    tbuffer_load_format_d16_xyzw v[54:55], v1, s[28:31], 0 format:[BUF_DATA_FORMAT_32_32_32_32,BUF_NUM_FORMAT_UINT] offen offset:3072 nt
    v_dot2_f32_bf16 v64, v96, s53, 0
    v_dot2_f32_bf16 v65, v96, s54, 0
    v_dot2_f32_bf16 v66, v97, s53, 0
    v_dot2_f32_bf16 v67, v97, s54, 0
    v_dot2_f32_bf16 v68, v98, s53, 0
    v_dot2_f32_bf16 v69, v98, s54, 0
    v_dot2_f32_bf16 v70, v99, s53, 0
    v_dot2_f32_bf16 v71, v99, s54, 0
    v_cvt_pk_f16_f32 v96, v64, v65
    v_cvt_pk_f16_f32 v97, v66, v67
    v_cvt_pk_f16_f32 v98, v68, v69
    v_cvt_pk_f16_f32 v99, v70, v71
    v_accvgpr_write_b32 a48, v96
    v_accvgpr_write_b32 a52, v97
    tbuffer_load_format_d16_xyzw v[56:57], v2, s[28:31], 0 format:[BUF_DATA_FORMAT_32_32_32_32,BUF_NUM_FORMAT_UINT] offen nt
    s_waitcnt lgkmcnt(2)
    v_accvgpr_write_b32 a49, v98
    v_accvgpr_write_b32 a53, v99
    v_dot2_f32_bf16 v64, v100, s53, 0
    v_dot2_f32_bf16 v65, v100, s54, 0
    v_dot2_f32_bf16 v66, v101, s53, 0
    v_dot2_f32_bf16 v67, v101, s54, 0
    v_dot2_f32_bf16 v68, v102, s53, 0
    v_dot2_f32_bf16 v69, v102, s54, 0
    v_dot2_f32_bf16 v70, v103, s53, 0
    v_dot2_f32_bf16 v71, v103, s54, 0
    v_cvt_pk_f16_f32 v100, v64, v65
    v_cvt_pk_f16_f32 v101, v66, v67
    v_cvt_pk_f16_f32 v102, v68, v69
    v_cvt_pk_f16_f32 v103, v70, v71
    tbuffer_load_format_d16_xyzw v[58:59], v2, s[28:31], 0 format:[BUF_DATA_FORMAT_32_32_32_32,BUF_NUM_FORMAT_UINT] offen offset:1024 nt
    v_accvgpr_write_b32 a50, v100
    s_waitcnt lgkmcnt(1)
    v_accvgpr_write_b32 a54, v101
    v_accvgpr_write_b32 a51, v102
    v_accvgpr_write_b32 a55, v103
    v_dot2_f32_bf16 v64, v128, s53, 0
    v_dot2_f32_bf16 v65, v128, s54, 0
    v_dot2_f32_bf16 v66, v129, s53, 0
    v_dot2_f32_bf16 v67, v129, s54, 0
    v_dot2_f32_bf16 v68, v130, s53, 0
    v_dot2_f32_bf16 v69, v130, s54, 0
    v_dot2_f32_bf16 v70, v131, s53, 0
    v_dot2_f32_bf16 v71, v131, s54, 0
    v_cvt_pk_f16_f32 v128, v64, v65
    v_cvt_pk_f16_f32 v129, v66, v67
    tbuffer_load_format_d16_xyzw v[60:61], v2, s[28:31], 0 format:[BUF_DATA_FORMAT_32_32_32_32,BUF_NUM_FORMAT_UINT] offen offset:2048 nt
    v_cvt_pk_f16_f32 v130, v68, v69
    v_cvt_pk_f16_f32 v131, v70, v71
    v_accvgpr_write_b32 a56, v128
    v_accvgpr_write_b32 a60, v129
    v_accvgpr_write_b32 a57, v130
    v_accvgpr_write_b32 a61, v131
    s_waitcnt lgkmcnt(0)
    v_dot2_f32_bf16 v64, v132, s53, 0
    v_dot2_f32_bf16 v65, v132, s54, 0
    v_dot2_f32_bf16 v66, v133, s53, 0
    v_dot2_f32_bf16 v67, v133, s54, 0
    v_dot2_f32_bf16 v68, v134, s53, 0
    v_dot2_f32_bf16 v69, v134, s54, 0
    v_dot2_f32_bf16 v70, v135, s53, 0
    v_dot2_f32_bf16 v71, v135, s54, 0
    tbuffer_load_format_d16_xyzw v[62:63], v2, s[28:31], 0 format:[BUF_DATA_FORMAT_32_32_32_32,BUF_NUM_FORMAT_UINT] offen offset:3072 nt
    v_cvt_pk_f16_f32 v132, v64, v65
    v_cvt_pk_f16_f32 v133, v66, v67
    v_cvt_pk_f16_f32 v134, v68, v69
    v_cvt_pk_f16_f32 v135, v70, v71
    v_accvgpr_write_b32 a58, v132
    v_accvgpr_write_b32 a62, v133
    v_accvgpr_write_b32 a59, v134
    v_accvgpr_write_b32 a63, v135
    v_mfma_f32_16x16x32_f16 v[96:99], a[148:151], a[48:51], v[12:15]
    s_waitcnt vmcnt(15)
    v_pk_fma_f16 v32, v32, v20, v22
    v_pk_fma_f16 v33, v33, v21, v23
    v_mfma_f32_16x16x32_f16 v[100:103], a[152:155], a[48:51], v[16:19]
    s_waitcnt vmcnt(14)
    v_pk_fma_f16 v34, v34, v20, v22
    ds_write_addtid_b32 v32 offset:16448
    v_mfma_f32_16x16x32_f16 v[128:131], a[156:159], a[48:51], v[180:183]
    v_pk_fma_f16 v35, v35, v21, v23
    ds_write_addtid_b32 v33 offset:16704
    v_mfma_f32_16x16x32_f16 v[132:135], a[160:163], a[48:51], v[184:187]
    s_waitcnt vmcnt(13)
    v_pk_fma_f16 v36, v36, v20, v22
    ds_write_addtid_b32 v34 offset:20560
    v_mfma_f32_16x16x32_f16 v[96:99], a[164:167], a[52:55], v[96:99]
    v_pk_fma_f16 v37, v37, v21, v23
    ds_write_addtid_b32 v35 offset:20816
    v_mfma_f32_16x16x32_f16 v[100:103], a[168:171], a[52:55], v[100:103]
    s_waitcnt vmcnt(12)
    v_pk_fma_f16 v38, v38, v20, v22
    ds_write_addtid_b32 v36 offset:16960
    v_mfma_f32_16x16x32_f16 v[128:131], a[172:175], a[52:55], v[128:131]
    v_pk_fma_f16 v39, v39, v21, v23
    ds_write_addtid_b32 v37 offset:17216
    v_mfma_f32_16x16x32_f16 v[132:135], a[176:179], a[52:55], v[132:135]
    s_waitcnt vmcnt(11)
    v_pk_fma_f16 v40, v40, v20, v22
    ds_write_addtid_b32 v38 offset:21072
    v_mfma_f32_16x16x32_f16 v[96:99], a[180:183], a[56:59], v[96:99]
    v_pk_fma_f16 v41, v41, v21, v23
    ds_write_addtid_b32 v39 offset:21328
    v_mfma_f32_16x16x32_f16 v[100:103], a[184:187], a[56:59], v[100:103]
    s_waitcnt vmcnt(10)
    v_pk_fma_f16 v42, v42, v20, v22
    ds_write_addtid_b32 v40 offset:24672
    v_mfma_f32_16x16x32_f16 v[128:131], a[188:191], a[56:59], v[128:131]
    v_pk_fma_f16 v43, v43, v21, v23
    ds_write_addtid_b32 v41 offset:24928
    v_mfma_f32_16x16x32_f16 v[132:135], a[192:195], a[56:59], v[132:135]
    s_waitcnt vmcnt(9)
    v_pk_fma_f16 v44, v44, v20, v22
    ds_write_addtid_b32 v42 offset:28784
    v_mfma_f32_16x16x32_f16 v[96:99], a[196:199], a[60:63], v[96:99]
    v_pk_fma_f16 v45, v45, v21, v23
    ds_write_addtid_b32 v43 offset:29040
    v_mfma_f32_16x16x32_f16 v[100:103], a[200:203], a[60:63], v[100:103]
    s_waitcnt vmcnt(8)
    v_pk_fma_f16 v46, v46, v20, v22
    ds_write_addtid_b32 v44 offset:25184
    v_mfma_f32_16x16x32_f16 v[128:131], a[204:207], a[60:63], v[128:131]
    v_pk_fma_f16 v47, v47, v21, v23
    ds_write_addtid_b32 v45 offset:25440
    v_mfma_f32_16x16x32_f16 v[132:135], a[208:211], a[60:63], v[132:135]
    s_waitcnt lgkmcnt(13)
    ds_write_addtid_b32 v46 offset:29296
    ds_write_addtid_b32 v47 offset:29552
    tbuffer_load_format_d16_xyzw v[32:33], v1, s[24:27], 0 format:[BUF_DATA_FORMAT_32_32_32_32,BUF_NUM_FORMAT_UINT] offen nt
    v_mfma_f32_16x16x32_bf16 v[160:163], a[112:115], v[72:75], 0
    v_exp_f32 v96, v96
    v_mfma_f32_16x16x32_bf16 v[164:167], a[116:119], v[72:75], 0
    v_exp_f32 v97, v97
    v_mfma_f32_16x16x32_bf16 v[168:171], a[120:123], v[72:75], 0
    v_exp_f32 v98, v98
    v_mfma_f32_16x16x32_bf16 v[172:175], a[124:127], v[72:75], 0
    tbuffer_load_format_d16_xyzw v[34:35], v1, s[24:27], 0 format:[BUF_DATA_FORMAT_32_32_32_32,BUF_NUM_FORMAT_UINT] offen offset:1024 nt
    v_exp_f32 v99, v99
    v_mfma_f32_16x16x32_bf16 v[176:179], a[128:131], v[72:75], 0
    v_cvt_pk_bf16_f32 v64, v96, v97
    v_exp_f32 v100, v100
    v_exp_f32 v101, v101
    v_cvt_pk_bf16_f32 v65, v98, v99
    v_exp_f32 v102, v102
    v_exp_f32 v103, v103
    tbuffer_load_format_d16_xyzw v[36:37], v1, s[24:27], 0 format:[BUF_DATA_FORMAT_32_32_32_32,BUF_NUM_FORMAT_UINT] offen offset:2048 nt
    v_cvt_pk_bf16_f32 v66, v100, v101
    v_cvt_pk_bf16_f32 v67, v102, v103
    s_nop 1
    v_mfma_f32_16x16x32_bf16 a[0:3], a[112:115], v[64:67], 0
    s_waitcnt lgkmcnt(13)
    ds_read_b128 v[12:15], v5 offset:256
    ds_read_b128 v[16:19], v5 offset:272
    v_mfma_f32_16x16x32_bf16 a[4:7], a[116:119], v[64:67], 0
    v_mov_b32 v180, 0
    v_mov_b32 v181, 0
    v_mfma_f32_16x16x32_bf16 a[8:11], a[120:123], v[64:67], 0
    v_mov_b32 v182, 0
    v_mov_b32 v183, 0
    tbuffer_load_format_d16_xyzw v[38:39], v1, s[24:27], 0 format:[BUF_DATA_FORMAT_32_32_32_32,BUF_NUM_FORMAT_UINT] offen offset:3072 nt
    v_mfma_f32_16x16x32_bf16 a[12:15], a[124:127], v[64:67], 0
    v_mov_b32 v184, 0
    v_mov_b32 v185, 0
    v_mfma_f32_16x16x32_bf16 a[16:19], a[128:131], v[64:67], 0
    v_mov_b32 v186, 0
    v_mov_b32 v187, 0
    v_mfma_f32_16x16x32_bf16 a[20:23], a[132:135], v[64:67], 0
    s_waitcnt lgkmcnt(2)
    s_barrier
    tbuffer_load_format_d16_xyzw v[40:41], v2, s[24:27], 0 format:[BUF_DATA_FORMAT_32_32_32_32,BUF_NUM_FORMAT_UINT] offen nt
    tbuffer_load_format_d16_xyzw v[42:43], v2, s[24:27], 0 format:[BUF_DATA_FORMAT_32_32_32_32,BUF_NUM_FORMAT_UINT] offen offset:1024 nt
    tbuffer_load_format_d16_xyzw v[44:45], v2, s[24:27], 0 format:[BUF_DATA_FORMAT_32_32_32_32,BUF_NUM_FORMAT_UINT] offen offset:2048 nt
    tbuffer_load_format_d16_xyzw v[46:47], v2, s[24:27], 0 format:[BUF_DATA_FORMAT_32_32_32_32,BUF_NUM_FORMAT_UINT] offen offset:3072 nt
    s_add_u32 s28, s28, 32768
    s_addc_u32 s29, s29, 0
    s_sub_u32 s30, s30, 32768
    s_max_i32 s30, s30, 0
.p2align 5
L_odd:
    v_exp_f32 v146, v146
    v_mfma_f32_16x16x32_bf16 v[180:183], a[132:135], v[72:75], v[180:183]
    s_waitcnt vmcnt(15)
    ds_read_b128 a[112:115], v3 offset:16448
    ds_write_addtid_b32 v48 offset:32896
    v_mfma_f32_16x16x32_bf16 v[212:215], a[132:135], v[80:83], v[212:215]
    v_exp_f32 v147, v147
    v_mfma_f32_16x16x32_bf16 v[244:247], a[132:135], v[88:91], v[244:247]
    ds_write_addtid_b32 v49 offset:33152
    v_cvt_pk_bf16_f32 v85, v146, v147
    v_mfma_f32_16x16x32_bf16 a[24:27], a[136:139], v[64:67], a[24:27]
    v_exp_f32 v148, v148
    v_mfma_f32_16x16x32_bf16 a[28:31], a[140:143], v[64:67], a[28:31]
    ds_read_b128 a[116:119], v3 offset:16960
    tbuffer_load_format_d16_xyzw v[48:49], v1, s[28:31], 0 format:[BUF_DATA_FORMAT_32_32_32_32,BUF_NUM_FORMAT_UINT] offen nt
    v_mfma_f32_16x16x32_bf16 v[188:191], a[140:143], v[72:75], v[188:191]
    v_exp_f32 v149, v149
    v_mfma_f32_16x16x32_bf16 v[184:187], a[136:139], v[72:75], v[184:187]
    ds_read_b128 v[20:23], v8 offset:1024
    v_cvt_pk_bf16_f32 v86, v148, v149
    v_mfma_f32_16x16x32_bf16 v[216:219], a[136:139], v[80:83], v[216:219]
    v_exp_f32 v150, v150
    v_mfma_f32_16x16x32_bf16 v[220:223], a[140:143], v[80:83], v[220:223]
    s_waitcnt vmcnt(15)
    ds_read_b128 a[120:123], v3 offset:16704
    ds_write_addtid_b32 v50 offset:37024
    v_mfma_f32_16x16x32_bf16 v[252:255], a[140:143], v[88:91], v[252:255]
    v_exp_f32 v151, v151
    v_mfma_f32_16x16x32_bf16 v[248:251], a[136:139], v[88:91], v[248:251]
    s_waitcnt lgkmcnt(6)
    ds_write_addtid_b32 v51 offset:37280
    v_cvt_pk_bf16_f32 v87, v150, v151
    v_mfma_f32_16x16x32_f16 v[120:123], a[112:115], a[96:99], v[12:15]
    s_waitcnt lgkmcnt(4)
    v_exp_f32 v136, v136
    v_mfma_f32_16x16x32_f16 v[124:127], a[116:119], a[96:99], v[16:19]
    ds_read_b128 a[124:127], v3 offset:17216
    tbuffer_load_format_d16_xyzw v[50:51], v1, s[28:31], 0 format:[BUF_DATA_FORMAT_32_32_32_32,BUF_NUM_FORMAT_UINT] offen offset:1024 nt
    v_mfma_f32_16x16x32_f16 v[116:119], a[116:119], a[80:83], v[16:19]
    v_exp_f32 v137, v137
    v_mfma_f32_16x16x32_f16 v[112:115], a[112:115], a[80:83], v[12:15]
    s_waitcnt vmcnt(15)
    ds_write_addtid_b32 v52 offset:33408
    v_cvt_pk_bf16_f32 v76, v136, v137
    v_mfma_f32_16x16x32_f16 v[104:107], a[112:115], a[64:67], v[12:15]
    v_exp_f32 v138, v138
    v_mfma_f32_16x16x32_f16 v[108:111], a[116:119], a[64:67], v[16:19]
    ds_read_b128 a[128:131], v3 offset:16464
    ds_write_addtid_b32 v53 offset:33664
    v_mfma_f32_16x16x32_f16 v[100:103], a[116:119], a[48:51], v[16:19]
    v_exp_f32 v139, v139
    v_mfma_f32_16x16x32_f16 v[96:99], a[112:115], a[48:51], v[12:15]
    s_waitcnt lgkmcnt(6)
    tbuffer_load_format_d16_xyzw v[52:53], v1, s[28:31], 0 format:[BUF_DATA_FORMAT_32_32_32_32,BUF_NUM_FORMAT_UINT] offen offset:2048 nt
    v_cvt_pk_bf16_f32 v77, v138, v139
    v_mfma_f32_16x16x32_f16 v[120:123], a[120:123], a[100:103], v[120:123]
    s_waitcnt lgkmcnt(3)
    v_exp_f32 v140, v140
    v_mfma_f32_16x16x32_f16 v[124:127], a[124:127], a[100:103], v[124:127]
    s_waitcnt vmcnt(15)
    ds_read_b128 a[132:135], v3 offset:16976
    ds_write_addtid_b32 v54 offset:37536
    v_mfma_f32_16x16x32_f16 v[116:119], a[124:127], a[84:87], v[116:119]
    v_exp_f32 v141, v141
    v_mfma_f32_16x16x32_f16 v[112:115], a[120:123], a[84:87], v[112:115]
    ds_write_addtid_b32 v55 offset:37792
    v_cvt_pk_bf16_f32 v78, v140, v141
    v_mfma_f32_16x16x32_f16 v[104:107], a[120:123], a[68:71], v[104:107]
    v_exp_f32 v142, v142
    v_mfma_f32_16x16x32_f16 v[108:111], a[124:127], a[68:71], v[108:111]
    ds_read_b128 a[136:139], v3 offset:16720
    tbuffer_load_format_d16_xyzw v[54:55], v1, s[28:31], 0 format:[BUF_DATA_FORMAT_32_32_32_32,BUF_NUM_FORMAT_UINT] offen offset:3072 nt
    v_mfma_f32_16x16x32_f16 v[100:103], a[124:127], a[52:55], v[100:103]
    v_exp_f32 v143, v143
    v_mfma_f32_16x16x32_f16 v[96:99], a[120:123], a[52:55], v[96:99]
    s_waitcnt lgkmcnt(5)
    ds_read_b128 v[12:15], v5 offset:384
    v_cvt_pk_bf16_f32 v79, v142, v143
    v_mfma_f32_16x16x32_f16 v[120:123], a[128:131], a[104:107], v[120:123]
    s_waitcnt lgkmcnt(4)
    v_exp_f32 v128, v128
    v_mfma_f32_16x16x32_f16 v[124:127], a[132:135], a[104:107], v[124:127]
    s_waitcnt vmcnt(15)
    ds_read_b128 a[140:143], v3 offset:17232
    ds_write_addtid_b32 v56 offset:41152
    v_mfma_f32_16x16x32_f16 v[116:119], a[132:135], a[88:91], v[116:119]
    v_exp_f32 v129, v129
    v_mfma_f32_16x16x32_f16 v[112:115], a[128:131], a[88:91], v[112:115]
    ds_read_b128 a[144:147], v6 offset:512
    v_cvt_pk_bf16_f32 v68, v128, v129
    v_mfma_f32_16x16x32_f16 v[104:107], a[128:131], a[72:75], v[104:107]
    s_add_u32 s24, s24, 32768
    v_exp_f32 v130, v130
    v_mfma_f32_16x16x32_f16 v[108:111], a[132:135], a[72:75], v[108:111]
    ds_read_b64_tr_b16 a[112:113], v4 offset:16512
    ds_write_addtid_b32 v57 offset:41408
    v_mfma_f32_16x16x32_f16 v[100:103], a[132:135], a[56:59], v[100:103]
    s_addc_u32 s25, s25, 0
    v_exp_f32 v131, v131
    v_mfma_f32_16x16x32_f16 v[96:99], a[128:131], a[56:59], v[96:99]
    s_waitcnt lgkmcnt(6)
    ds_read_b64_tr_b16 a[114:115], v4 offset:17024
    v_cvt_pk_bf16_f32 v69, v130, v131
    v_mfma_f32_16x16x32_f16 v[120:123], a[136:139], a[108:111], v[120:123]
    s_waitcnt lgkmcnt(5)
    v_exp_f32 v132, v132
    v_mfma_f32_16x16x32_f16 v[124:127], a[140:143], a[108:111], v[124:127]
    s_sub_u32 s26, s26, 32768
    ds_read_b64_tr_b16 a[116:117], v4 offset:16768
    tbuffer_load_format_d16_xyzw v[56:57], v2, s[28:31], 0 format:[BUF_DATA_FORMAT_32_32_32_32,BUF_NUM_FORMAT_UINT] offen nt
    v_mfma_f32_16x16x32_f16 v[116:119], a[140:143], a[92:95], v[116:119]
    s_max_i32 s26, s26, 0
    v_exp_f32 v133, v133
    v_mfma_f32_16x16x32_f16 v[112:115], a[136:139], a[92:95], v[112:115]
    ds_read_b64_tr_b16 a[118:119], v4 offset:17280
    v_cvt_pk_bf16_f32 v70, v132, v133
    v_mfma_f32_16x16x32_f16 v[104:107], a[136:139], a[76:79], v[104:107]
    v_exp_f32 v134, v134
    v_mfma_f32_16x16x32_f16 v[108:111], a[140:143], a[76:79], v[108:111]
    s_waitcnt vmcnt(15)
    ds_read_b64_tr_b16 a[120:121], v4 offset:16544
    ds_write_addtid_b32 v58 offset:45280
    v_mfma_f32_16x16x32_f16 v[100:103], a[140:143], a[60:63], v[100:103]
    v_exp_f32 v135, v135
    v_mfma_f32_16x16x32_f16 v[96:99], a[136:139], a[60:63], v[96:99]
    s_waitcnt lgkmcnt(7)
    ds_read_b64_tr_b16 a[122:123], v4 offset:17056
    v_cvt_pk_bf16_f32 v71, v134, v135
    v_smfmac_f32_16x16x64_bf16 a[44:47], a[144:147], v[88:95], v31
    v_exp_f32 v120, v120
    v_smfmac_f32_16x16x64_bf16 a[40:43], a[144:147], v[80:87], v31
    ds_read_b64_tr_b16 a[124:125], v4 offset:16800
    v_smfmac_f32_16x16x64_bf16 a[36:39], a[144:147], v[72:79], v31
    v_exp_f32 v121, v121
    v_smfmac_f32_16x16x64_bf16 a[32:35], a[144:147], v[64:71], v31
    s_waitcnt lgkmcnt(6)
    ds_read_b64_tr_b16 a[126:127], v4 offset:17312
    v_cvt_pk_bf16_f32 v88, v120, v121
    v_mfma_f32_16x16x32_bf16 v[224:227], a[112:115], v[92:95], v[224:227]
    s_waitcnt lgkmcnt(5)
    v_exp_f32 v122, v122
    v_mfma_f32_16x16x32_bf16 v[228:231], a[116:119], v[92:95], v[228:231]
    ds_read_b64_tr_b16 a[128:129], v4 offset:16576
    ds_write_addtid_b32 v59 offset:45536
    v_mfma_f32_16x16x32_bf16 v[196:199], a[116:119], v[84:87], v[196:199]
    v_exp_f32 v123, v123
    v_mfma_f32_16x16x32_bf16 v[192:195], a[112:115], v[84:87], v[192:195]
    ds_read_b64_tr_b16 a[130:131], v4 offset:17088
    v_cvt_pk_bf16_f32 v89, v122, v123
    v_mfma_f32_16x16x32_bf16 v[160:163], a[112:115], v[76:79], v[160:163]
    v_exp_f32 v124, v124
    v_mfma_f32_16x16x32_bf16 v[164:167], a[116:119], v[76:79], v[164:167]
    ds_read_b64_tr_b16 a[132:133], v4 offset:16832
    tbuffer_load_format_d16_xyzw v[58:59], v2, s[28:31], 0 format:[BUF_DATA_FORMAT_32_32_32_32,BUF_NUM_FORMAT_UINT] offen offset:1024 nt
    v_mfma_f32_16x16x32_bf16 a[4:7], a[116:119], v[68:71], a[4:7]
    v_exp_f32 v125, v125
    v_mfma_f32_16x16x32_bf16 a[0:3], a[112:115], v[68:71], a[0:3]
    s_waitcnt lgkmcnt(6)
    ds_read_b64_tr_b16 a[134:135], v4 offset:17344
    v_cvt_pk_bf16_f32 v90, v124, v125
    v_mfma_f32_16x16x32_bf16 a[8:11], a[120:123], v[68:71], a[8:11]
    s_waitcnt lgkmcnt(5)
    v_exp_f32 v126, v126
    v_mfma_f32_16x16x32_bf16 a[12:15], a[124:127], v[68:71], a[12:15]
    s_waitcnt vmcnt(15)
    ds_read_b64_tr_b16 a[136:137], v4 offset:16608
    ds_write_addtid_b32 v60 offset:41664
    v_mfma_f32_16x16x32_bf16 v[172:175], a[124:127], v[76:79], v[172:175]
    v_exp_f32 v127, v127
    v_mfma_f32_16x16x32_bf16 v[168:171], a[120:123], v[76:79], v[168:171]
    ds_read_b64_tr_b16 a[138:139], v4 offset:17120
    ds_write_addtid_b32 v61 offset:41920
    v_cvt_pk_bf16_f32 v91, v126, v127
    v_mfma_f32_16x16x32_bf16 v[200:203], a[120:123], v[84:87], v[200:203]
    v_exp_f32 v112, v112
    v_mfma_f32_16x16x32_bf16 v[204:207], a[124:127], v[84:87], v[204:207]
    ds_read_b64_tr_b16 a[140:141], v4 offset:16864
    tbuffer_load_format_d16_xyzw v[60:61], v2, s[28:31], 0 format:[BUF_DATA_FORMAT_32_32_32_32,BUF_NUM_FORMAT_UINT] offen offset:2048 nt
    v_mfma_f32_16x16x32_bf16 v[236:239], a[124:127], v[92:95], v[236:239]
    v_exp_f32 v113, v113
    v_mfma_f32_16x16x32_bf16 v[232:235], a[120:123], v[92:95], v[232:235]
    s_waitcnt lgkmcnt(7)
    ds_read_b64_tr_b16 a[142:143], v4 offset:17376
    v_cvt_pk_bf16_f32 v80, v112, v113
    v_mfma_f32_16x16x32_bf16 v[240:243], a[128:131], v[92:95], v[240:243]
    s_waitcnt lgkmcnt(6)
    v_exp_f32 v114, v114
    v_mfma_f32_16x16x32_bf16 v[244:247], a[132:135], v[92:95], v[244:247]
    s_waitcnt vmcnt(15)
    ds_read_b128 a[112:115], v3 offset:17472
    ds_write_addtid_b32 v62 offset:45792
    v_mfma_f32_16x16x32_bf16 v[212:215], a[132:135], v[84:87], v[212:215]
    v_exp_f32 v115, v115
    v_mfma_f32_16x16x32_bf16 v[208:211], a[128:131], v[84:87], v[208:211]
    ds_read_b128 v[16:19], v5 offset:400
    v_cvt_pk_bf16_f32 v81, v114, v115
    v_mfma_f32_16x16x32_bf16 v[176:179], a[128:131], v[76:79], v[176:179]
    v_exp_f32 v116, v116
    v_mfma_f32_16x16x32_bf16 v[180:183], a[132:135], v[76:79], v[180:183]
    ds_read_b128 a[116:119], v3 offset:17984
    ds_write_addtid_b32 v63 offset:46048
    v_mfma_f32_16x16x32_bf16 a[20:23], a[132:135], v[68:71], a[20:23]
    s_waitcnt vmcnt(14)
    v_exp_f32 v117, v117
    v_pk_fma_f16 v32, v32, v20, v22
    v_mfma_f32_16x16x32_bf16 a[16:19], a[128:131], v[68:71], a[16:19]
    s_waitcnt lgkmcnt(8)
    tbuffer_load_format_d16_xyzw v[62:63], v2, s[28:31], 0 format:[BUF_DATA_FORMAT_32_32_32_32,BUF_NUM_FORMAT_UINT] offen offset:3072 nt
    v_cvt_pk_bf16_f32 v82, v116, v117
    v_mfma_f32_16x16x32_bf16 a[24:27], a[136:139], v[68:71], a[24:27]
    s_waitcnt lgkmcnt(5)
    v_exp_f32 v118, v118
    v_pk_fma_f16 v33, v33, v21, v23
    v_mfma_f32_16x16x32_bf16 a[28:31], a[140:143], v[68:71], a[28:31]
    ds_read_b128 a[120:123], v3 offset:17728
    ds_write_addtid_b32 v32
    v_mfma_f32_16x16x32_bf16 v[188:191], a[140:143], v[76:79], v[188:191]
    v_exp_f32 v119, v119
    v_mfma_f32_16x16x32_bf16 v[184:187], a[136:139], v[76:79], v[184:187]
    ds_write_addtid_b32 v33 offset:256
    v_cvt_pk_bf16_f32 v83, v118, v119
    v_mfma_f32_16x16x32_bf16 v[216:219], a[136:139], v[84:87], v[216:219]
    s_waitcnt vmcnt(14)
    v_exp_f32 v104, v104
    v_pk_fma_f16 v34, v34, v20, v22
    v_mfma_f32_16x16x32_bf16 v[220:223], a[140:143], v[84:87], v[220:223]
    ds_read_b128 a[124:127], v3 offset:18240
    tbuffer_load_format_d16_xyzw v[32:33], v1, s[24:27], 0 format:[BUF_DATA_FORMAT_32_32_32_32,BUF_NUM_FORMAT_UINT] offen nt
    v_mfma_f32_16x16x32_bf16 v[252:255], a[140:143], v[92:95], v[252:255]
    v_exp_f32 v105, v105
    v_pk_fma_f16 v35, v35, v21, v23
    v_mfma_f32_16x16x32_bf16 v[248:251], a[136:139], v[92:95], v[248:251]
    s_waitcnt lgkmcnt(8)
    ds_write_addtid_b32 v34 offset:4112
    v_cvt_pk_bf16_f32 v72, v104, v105
    v_mfma_f32_16x16x32_f16 v[152:155], a[112:115], a[96:99], v[12:15]
    s_waitcnt lgkmcnt(6)
    v_exp_f32 v106, v106
    v_mfma_f32_16x16x32_f16 v[156:159], a[116:119], a[96:99], v[16:19]
    ds_read_b128 a[128:131], v3 offset:17488
    ds_write_addtid_b32 v35 offset:4368
    v_mfma_f32_16x16x32_f16 v[148:151], a[116:119], a[80:83], v[16:19]
    s_waitcnt vmcnt(14)
    v_exp_f32 v107, v107
    v_pk_fma_f16 v36, v36, v20, v22
    v_mfma_f32_16x16x32_f16 v[144:147], a[112:115], a[80:83], v[12:15]
    tbuffer_load_format_d16_xyzw v[34:35], v1, s[24:27], 0 format:[BUF_DATA_FORMAT_32_32_32_32,BUF_NUM_FORMAT_UINT] offen offset:1024 nt
    v_cvt_pk_bf16_f32 v73, v106, v107
    v_mfma_f32_16x16x32_f16 v[136:139], a[112:115], a[64:67], v[12:15]
    v_exp_f32 v108, v108
    v_pk_fma_f16 v37, v37, v21, v23
    v_mfma_f32_16x16x32_f16 v[140:143], a[116:119], a[64:67], v[16:19]
    ds_read_b128 a[132:135], v3 offset:18000
    ds_write_addtid_b32 v36 offset:512
    v_mfma_f32_16x16x32_f16 v[132:135], a[116:119], a[48:51], v[16:19]
    v_exp_f32 v109, v109
    v_mfma_f32_16x16x32_f16 v[128:131], a[112:115], a[48:51], v[12:15]
    s_waitcnt lgkmcnt(8)
    ds_write_addtid_b32 v37 offset:768
    v_cvt_pk_bf16_f32 v74, v108, v109
    v_mfma_f32_16x16x32_f16 v[152:155], a[120:123], a[100:103], v[152:155]
    s_waitcnt vmcnt(14) lgkmcnt(6)
    v_exp_f32 v110, v110
    v_pk_fma_f16 v38, v38, v20, v22
    v_mfma_f32_16x16x32_f16 v[156:159], a[124:127], a[100:103], v[156:159]
    ds_read_b128 a[136:139], v3 offset:17744
    tbuffer_load_format_d16_xyzw v[36:37], v1, s[24:27], 0 format:[BUF_DATA_FORMAT_32_32_32_32,BUF_NUM_FORMAT_UINT] offen offset:2048 nt
    v_mfma_f32_16x16x32_f16 v[148:151], a[124:127], a[84:87], v[148:151]
    v_exp_f32 v111, v111
    v_pk_fma_f16 v39, v39, v21, v23
    v_mfma_f32_16x16x32_f16 v[144:147], a[120:123], a[84:87], v[144:147]
    ds_write_addtid_b32 v38 offset:4624
    v_cvt_pk_bf16_f32 v75, v110, v111
    v_mfma_f32_16x16x32_f16 v[136:139], a[120:123], a[68:71], v[136:139]
    v_exp_f32 v96, v96
    v_mfma_f32_16x16x32_f16 v[140:143], a[124:127], a[68:71], v[140:143]
    ds_read_b128 a[140:143], v3 offset:18256
    ds_write_addtid_b32 v39 offset:4880
    v_mfma_f32_16x16x32_f16 v[132:135], a[124:127], a[52:55], v[132:135]
    v_exp_f32 v97, v97
    v_mfma_f32_16x16x32_f16 v[128:131], a[120:123], a[52:55], v[128:131]
    s_waitcnt lgkmcnt(8)
    ds_read_b64_tr_b16 a[112:113], v4 offset:17536
    v_cvt_pk_bf16_f32 v64, v96, v97
    v_mfma_f32_16x16x32_f16 v[152:155], a[128:131], a[104:107], v[152:155]
    s_waitcnt vmcnt(14) lgkmcnt(7)
    v_exp_f32 v98, v98
    v_pk_fma_f16 v40, v40, v20, v22
    v_mfma_f32_16x16x32_f16 v[156:159], a[132:135], a[104:107], v[156:159]
    ds_read_b64_tr_b16 a[114:115], v4 offset:18048
    tbuffer_load_format_d16_xyzw v[38:39], v1, s[24:27], 0 format:[BUF_DATA_FORMAT_32_32_32_32,BUF_NUM_FORMAT_UINT] offen offset:3072 nt
    v_mfma_f32_16x16x32_f16 v[148:151], a[132:135], a[88:91], v[148:151]
    v_exp_f32 v99, v99
    v_pk_fma_f16 v41, v41, v21, v23
    v_mfma_f32_16x16x32_f16 v[144:147], a[128:131], a[88:91], v[144:147]
    ds_read_b64_tr_b16 a[116:117], v4 offset:17792
    v_cvt_pk_bf16_f32 v65, v98, v99
    v_mfma_f32_16x16x32_f16 v[136:139], a[128:131], a[72:75], v[136:139]
    s_waitcnt vmcnt(14)
    v_exp_f32 v100, v100
    v_pk_fma_f16 v42, v42, v20, v22
    v_mfma_f32_16x16x32_f16 v[140:143], a[132:135], a[72:75], v[140:143]
    ds_read_b64_tr_b16 a[118:119], v4 offset:18304
    ds_write_addtid_b32 v40 offset:8224
    v_mfma_f32_16x16x32_f16 v[132:135], a[132:135], a[56:59], v[132:135]
    v_exp_f32 v101, v101
    v_pk_fma_f16 v43, v43, v21, v23
    v_mfma_f32_16x16x32_f16 v[128:131], a[128:131], a[56:59], v[128:131]
    s_waitcnt lgkmcnt(8)
    ds_read_b64_tr_b16 a[120:121], v4 offset:17568
    v_cvt_pk_bf16_f32 v66, v100, v101
    v_mfma_f32_16x16x32_f16 v[152:155], a[136:139], a[108:111], v[152:155]
    s_waitcnt vmcnt(13) lgkmcnt(7)
    v_exp_f32 v102, v102
    v_pk_fma_f16 v44, v44, v20, v22
    v_mfma_f32_16x16x32_f16 v[156:159], a[140:143], a[108:111], v[156:159]
    ds_read_b64_tr_b16 a[122:123], v4 offset:18080
    ds_write_addtid_b32 v41 offset:8480
    v_mfma_f32_16x16x32_f16 v[148:151], a[140:143], a[92:95], v[148:151]
    v_exp_f32 v103, v103
    v_pk_fma_f16 v45, v45, v21, v23
    v_mfma_f32_16x16x32_f16 v[144:147], a[136:139], a[92:95], v[144:147]
    ds_read_b64_tr_b16 a[124:125], v4 offset:17824
    tbuffer_load_format_d16_xyzw v[40:41], v2, s[24:27], 0 format:[BUF_DATA_FORMAT_32_32_32_32,BUF_NUM_FORMAT_UINT] offen nt
    v_cvt_pk_bf16_f32 v67, v102, v103
    v_mfma_f32_16x16x32_f16 v[136:139], a[136:139], a[76:79], v[136:139]
    ds_write_addtid_b32 v42 offset:12336
    v_add_u32 v8, 1024, v8
    v_mfma_f32_16x16x32_f16 v[140:143], a[140:143], a[76:79], v[140:143]
    ds_read_b64_tr_b16 a[126:127], v4 offset:18336
    ds_write_addtid_b32 v43 offset:12592
    v_mfma_f32_16x16x32_f16 v[132:135], a[140:143], a[60:63], v[132:135]
    tbuffer_load_format_d16_xyzw v[42:43], v2, s[24:27], 0 format:[BUF_DATA_FORMAT_32_32_32_32,BUF_NUM_FORMAT_UINT] offen offset:1024 nt
    v_add_u32 v6, 0x400, v6
    v_mfma_f32_16x16x32_f16 v[128:131], a[136:139], a[60:63], v[128:131]
    s_waitcnt lgkmcnt(10)
    ds_read_b64_tr_b16 a[128:129], v4 offset:17600
    ds_write_addtid_b32 v44 offset:8736
    v_mfma_f32_16x16x32_bf16 v[224:227], a[112:115], v[88:91], v[224:227]
    s_waitcnt lgkmcnt(10)
    v_exp_f32 v152, v152
    v_mfma_f32_16x16x32_bf16 v[228:231], a[116:119], v[88:91], v[228:231]
    s_add_u32 s28, s28, 32768
    ds_read_b64_tr_b16 a[130:131], v4 offset:18112
    ds_write_addtid_b32 v45 offset:8992
    v_mfma_f32_16x16x32_bf16 v[196:199], a[116:119], v[80:83], v[196:199]
    s_addc_u32 s29, s29, 0
    v_exp_f32 v153, v153
    v_mfma_f32_16x16x32_bf16 v[192:195], a[112:115], v[80:83], v[192:195]
    ds_read_b64_tr_b16 a[132:133], v4 offset:17856
    v_cvt_pk_bf16_f32 v92, v152, v153
    v_mfma_f32_16x16x32_bf16 v[160:163], a[112:115], v[72:75], v[160:163]
    s_sub_u32 s30, s30, 32768
    v_exp_f32 v154, v154
    v_mfma_f32_16x16x32_bf16 v[164:167], a[116:119], v[72:75], v[164:167]
    ds_read_b64_tr_b16 a[134:135], v4 offset:18368
    tbuffer_load_format_d16_xyzw v[44:45], v2, s[24:27], 0 format:[BUF_DATA_FORMAT_32_32_32_32,BUF_NUM_FORMAT_UINT] offen offset:2048 nt
    v_mfma_f32_16x16x32_bf16 a[4:7], a[116:119], v[64:67], a[4:7]
    s_waitcnt vmcnt(15)
    v_exp_f32 v155, v155
    v_pk_fma_f16 v46, v46, v20, v22
    v_mfma_f32_16x16x32_bf16 a[0:3], a[112:115], v[64:67], a[0:3]
    s_waitcnt lgkmcnt(11)
    ds_read_b64_tr_b16 a[136:137], v4 offset:17632
    v_cvt_pk_bf16_f32 v93, v154, v155
    v_mfma_f32_16x16x32_bf16 a[8:11], a[120:123], v[64:67], a[8:11]
    s_waitcnt lgkmcnt(8)
    v_exp_f32 v156, v156
    v_mfma_f32_16x16x32_bf16 a[12:15], a[124:127], v[64:67], a[12:15]
    s_max_i32 s30, s30, 0
    ds_read_b64_tr_b16 a[138:139], v4 offset:18144
    ds_write_addtid_b32 v46 offset:12848
    v_mfma_f32_16x16x32_bf16 v[172:175], a[124:127], v[72:75], v[172:175]
    v_exp_f32 v157, v157
    v_pk_fma_f16 v47, v47, v21, v23
    v_mfma_f32_16x16x32_bf16 v[168:171], a[120:123], v[72:75], v[168:171]
    ds_read_b64_tr_b16 a[140:141], v4 offset:17888
    v_cvt_pk_bf16_f32 v94, v156, v157
    v_mfma_f32_16x16x32_bf16 v[200:203], a[120:123], v[80:83], v[200:203]
    v_exp_f32 v158, v158
    v_mfma_f32_16x16x32_bf16 v[204:207], a[124:127], v[80:83], v[204:207]
    ds_read_b64_tr_b16 a[142:143], v4 offset:18400
    ds_write_addtid_b32 v47 offset:13104
    v_mfma_f32_16x16x32_bf16 v[236:239], a[124:127], v[88:91], v[236:239]
    v_exp_f32 v159, v159
    v_mfma_f32_16x16x32_bf16 v[232:235], a[120:123], v[88:91], v[232:235]
    s_waitcnt lgkmcnt(9)
    ds_read_b128 v[12:15], v5 offset:512
    v_cvt_pk_bf16_f32 v95, v158, v159
    v_mfma_f32_16x16x32_bf16 v[240:243], a[128:131], v[88:91], v[240:243]
    s_sub_u32 s55, s55, 1
    v_exp_f32 v144, v144
    v_mfma_f32_16x16x32_bf16 v[208:211], a[128:131], v[80:83], v[208:211]
    ds_read_b128 v[16:19], v5 offset:528
    tbuffer_load_format_d16_xyzw v[46:47], v2, s[24:27], 0 format:[BUF_DATA_FORMAT_32_32_32_32,BUF_NUM_FORMAT_UINT] offen offset:3072 nt
    v_mfma_f32_16x16x32_bf16 v[176:179], a[128:131], v[72:75], v[176:179]
    s_waitcnt lgkmcnt(2)
    v_exp_f32 v145, v145
    v_mfma_f32_16x16x32_bf16 a[16:19], a[128:131], v[64:67], a[16:19]
    s_barrier
    v_cvt_pk_bf16_f32 v84, v144, v145
    v_add_u32 v5, 512, v5
    v_mfma_f32_16x16x32_bf16 a[20:23], a[132:135], v[64:67], a[20:23]
    s_cbranch_scc1 L_tail
L_even:
    v_exp_f32 v146, v146
    v_mfma_f32_16x16x32_bf16 v[180:183], a[132:135], v[72:75], v[180:183]
    s_waitcnt vmcnt(15)
    ds_read_b128 a[112:115], v3
    ds_write_addtid_b32 v48 offset:49408
    v_mfma_f32_16x16x32_bf16 v[212:215], a[132:135], v[80:83], v[212:215]
    v_exp_f32 v147, v147
    v_mfma_f32_16x16x32_bf16 v[244:247], a[132:135], v[88:91], v[244:247]
    ds_write_addtid_b32 v49 offset:49664
    v_cvt_pk_bf16_f32 v85, v146, v147
    v_mfma_f32_16x16x32_bf16 a[24:27], a[136:139], v[64:67], a[24:27]
    v_exp_f32 v148, v148
    v_mfma_f32_16x16x32_bf16 a[28:31], a[140:143], v[64:67], a[28:31]
    ds_read_b128 a[116:119], v3 offset:512
    tbuffer_load_format_d16_xyzw v[48:49], v1, s[28:31], 0 format:[BUF_DATA_FORMAT_32_32_32_32,BUF_NUM_FORMAT_UINT] offen nt
    v_mfma_f32_16x16x32_bf16 v[188:191], a[140:143], v[72:75], v[188:191]
    v_exp_f32 v149, v149
    v_mfma_f32_16x16x32_bf16 v[184:187], a[136:139], v[72:75], v[184:187]
    ds_read_b128 v[20:23], v8 offset:512
    v_cvt_pk_bf16_f32 v86, v148, v149
    v_mfma_f32_16x16x32_bf16 v[216:219], a[136:139], v[80:83], v[216:219]
    v_exp_f32 v150, v150
    v_mfma_f32_16x16x32_bf16 v[220:223], a[140:143], v[80:83], v[220:223]
    s_waitcnt vmcnt(15)
    ds_read_b128 a[120:123], v3 offset:256
    ds_write_addtid_b32 v50 offset:53536
    v_mfma_f32_16x16x32_bf16 v[252:255], a[140:143], v[88:91], v[252:255]
    v_exp_f32 v151, v151
    v_mfma_f32_16x16x32_bf16 v[248:251], a[136:139], v[88:91], v[248:251]
    s_waitcnt lgkmcnt(6)
    ds_write_addtid_b32 v51 offset:53792
    v_cvt_pk_bf16_f32 v87, v150, v151
    v_mfma_f32_16x16x32_f16 v[120:123], a[112:115], a[96:99], v[12:15]
    s_waitcnt lgkmcnt(4)
    v_exp_f32 v136, v136
    v_mfma_f32_16x16x32_f16 v[124:127], a[116:119], a[96:99], v[16:19]
    ds_read_b128 a[124:127], v3 offset:768
    tbuffer_load_format_d16_xyzw v[50:51], v1, s[28:31], 0 format:[BUF_DATA_FORMAT_32_32_32_32,BUF_NUM_FORMAT_UINT] offen offset:1024 nt
    v_mfma_f32_16x16x32_f16 v[116:119], a[116:119], a[80:83], v[16:19]
    v_exp_f32 v137, v137
    v_mfma_f32_16x16x32_f16 v[112:115], a[112:115], a[80:83], v[12:15]
    s_waitcnt vmcnt(15)
    ds_write_addtid_b32 v52 offset:49920
    v_cvt_pk_bf16_f32 v76, v136, v137
    v_mfma_f32_16x16x32_f16 v[104:107], a[112:115], a[64:67], v[12:15]
    v_exp_f32 v138, v138
    v_mfma_f32_16x16x32_f16 v[108:111], a[116:119], a[64:67], v[16:19]
    ds_read_b128 a[128:131], v3 offset:16
    ds_write_addtid_b32 v53 offset:50176
    v_mfma_f32_16x16x32_f16 v[100:103], a[116:119], a[48:51], v[16:19]
    v_exp_f32 v139, v139
    v_mfma_f32_16x16x32_f16 v[96:99], a[112:115], a[48:51], v[12:15]
    s_waitcnt lgkmcnt(6)
    tbuffer_load_format_d16_xyzw v[52:53], v1, s[28:31], 0 format:[BUF_DATA_FORMAT_32_32_32_32,BUF_NUM_FORMAT_UINT] offen offset:2048 nt
    v_cvt_pk_bf16_f32 v77, v138, v139
    v_mfma_f32_16x16x32_f16 v[120:123], a[120:123], a[100:103], v[120:123]
    s_waitcnt lgkmcnt(3)
    v_exp_f32 v140, v140
    v_mfma_f32_16x16x32_f16 v[124:127], a[124:127], a[100:103], v[124:127]
    s_waitcnt vmcnt(15)
    ds_read_b128 a[132:135], v3 offset:528
    ds_write_addtid_b32 v54 offset:54048
    v_mfma_f32_16x16x32_f16 v[116:119], a[124:127], a[84:87], v[116:119]
    v_exp_f32 v141, v141
    v_mfma_f32_16x16x32_f16 v[112:115], a[120:123], a[84:87], v[112:115]
    ds_write_addtid_b32 v55 offset:54304
    v_cvt_pk_bf16_f32 v78, v140, v141
    v_mfma_f32_16x16x32_f16 v[104:107], a[120:123], a[68:71], v[104:107]
    v_exp_f32 v142, v142
    v_mfma_f32_16x16x32_f16 v[108:111], a[124:127], a[68:71], v[108:111]
    ds_read_b128 a[136:139], v3 offset:272
    tbuffer_load_format_d16_xyzw v[54:55], v1, s[28:31], 0 format:[BUF_DATA_FORMAT_32_32_32_32,BUF_NUM_FORMAT_UINT] offen offset:3072 nt
    v_mfma_f32_16x16x32_f16 v[100:103], a[124:127], a[52:55], v[100:103]
    v_exp_f32 v143, v143
    v_mfma_f32_16x16x32_f16 v[96:99], a[120:123], a[52:55], v[96:99]
    s_waitcnt lgkmcnt(5)
    ds_read_b128 v[12:15], v5 offset:128
    v_cvt_pk_bf16_f32 v79, v142, v143
    v_mfma_f32_16x16x32_f16 v[120:123], a[128:131], a[104:107], v[120:123]
    s_waitcnt lgkmcnt(4)
    v_exp_f32 v128, v128
    v_mfma_f32_16x16x32_f16 v[124:127], a[132:135], a[104:107], v[124:127]
    s_waitcnt vmcnt(15)
    ds_read_b128 a[140:143], v3 offset:784
    ds_write_addtid_b32 v56 offset:57664
    v_mfma_f32_16x16x32_f16 v[116:119], a[132:135], a[88:91], v[116:119]
    v_exp_f32 v129, v129
    v_mfma_f32_16x16x32_f16 v[112:115], a[128:131], a[88:91], v[112:115]
    ds_read_b128 a[144:147], v6
    v_cvt_pk_bf16_f32 v68, v128, v129
    v_mfma_f32_16x16x32_f16 v[104:107], a[128:131], a[72:75], v[104:107]
    s_add_u32 s24, s24, 32768
    v_exp_f32 v130, v130
    v_mfma_f32_16x16x32_f16 v[108:111], a[132:135], a[72:75], v[108:111]
    ds_read_b64_tr_b16 a[112:113], v4
    ds_write_addtid_b32 v57 offset:57920
    v_mfma_f32_16x16x32_f16 v[100:103], a[132:135], a[56:59], v[100:103]
    s_addc_u32 s25, s25, 0
    v_exp_f32 v131, v131
    v_mfma_f32_16x16x32_f16 v[96:99], a[128:131], a[56:59], v[96:99]
    s_waitcnt lgkmcnt(6)
    ds_read_b64_tr_b16 a[114:115], v4 offset:512
    v_cvt_pk_bf16_f32 v69, v130, v131
    v_mfma_f32_16x16x32_f16 v[120:123], a[136:139], a[108:111], v[120:123]
    s_waitcnt lgkmcnt(5)
    v_exp_f32 v132, v132
    v_mfma_f32_16x16x32_f16 v[124:127], a[140:143], a[108:111], v[124:127]
    s_sub_u32 s26, s26, 32768
    ds_read_b64_tr_b16 a[116:117], v4 offset:256
    tbuffer_load_format_d16_xyzw v[56:57], v2, s[28:31], 0 format:[BUF_DATA_FORMAT_32_32_32_32,BUF_NUM_FORMAT_UINT] offen nt
    v_mfma_f32_16x16x32_f16 v[116:119], a[140:143], a[92:95], v[116:119]
    s_max_i32 s26, s26, 0
    v_exp_f32 v133, v133
    v_mfma_f32_16x16x32_f16 v[112:115], a[136:139], a[92:95], v[112:115]
    ds_read_b64_tr_b16 a[118:119], v4 offset:768
    v_cvt_pk_bf16_f32 v70, v132, v133
    v_mfma_f32_16x16x32_f16 v[104:107], a[136:139], a[76:79], v[104:107]
    v_exp_f32 v134, v134
    v_mfma_f32_16x16x32_f16 v[108:111], a[140:143], a[76:79], v[108:111]
    s_waitcnt vmcnt(15)
    ds_read_b64_tr_b16 a[120:121], v4 offset:32
    ds_write_addtid_b32 v58 offset:61792
    v_mfma_f32_16x16x32_f16 v[100:103], a[140:143], a[60:63], v[100:103]
    v_exp_f32 v135, v135
    v_mfma_f32_16x16x32_f16 v[96:99], a[136:139], a[60:63], v[96:99]
    s_waitcnt lgkmcnt(7)
    ds_read_b64_tr_b16 a[122:123], v4 offset:544
    v_cvt_pk_bf16_f32 v71, v134, v135
    v_smfmac_f32_16x16x64_bf16 a[44:47], a[144:147], v[88:95], v31
    v_exp_f32 v120, v120
    v_smfmac_f32_16x16x64_bf16 a[40:43], a[144:147], v[80:87], v31
    ds_read_b64_tr_b16 a[124:125], v4 offset:288
    v_smfmac_f32_16x16x64_bf16 a[36:39], a[144:147], v[72:79], v31
    v_exp_f32 v121, v121
    v_smfmac_f32_16x16x64_bf16 a[32:35], a[144:147], v[64:71], v31
    s_waitcnt lgkmcnt(6)
    ds_read_b64_tr_b16 a[126:127], v4 offset:800
    v_cvt_pk_bf16_f32 v88, v120, v121
    v_mfma_f32_16x16x32_bf16 v[224:227], a[112:115], v[92:95], v[224:227]
    s_waitcnt lgkmcnt(5)
    v_exp_f32 v122, v122
    v_mfma_f32_16x16x32_bf16 v[228:231], a[116:119], v[92:95], v[228:231]
    ds_read_b64_tr_b16 a[128:129], v4 offset:64
    ds_write_addtid_b32 v59 offset:62048
    v_mfma_f32_16x16x32_bf16 v[196:199], a[116:119], v[84:87], v[196:199]
    v_exp_f32 v123, v123
    v_mfma_f32_16x16x32_bf16 v[192:195], a[112:115], v[84:87], v[192:195]
    ds_read_b64_tr_b16 a[130:131], v4 offset:576
    v_cvt_pk_bf16_f32 v89, v122, v123
    v_mfma_f32_16x16x32_bf16 v[160:163], a[112:115], v[76:79], v[160:163]
    v_exp_f32 v124, v124
    v_mfma_f32_16x16x32_bf16 v[164:167], a[116:119], v[76:79], v[164:167]
    ds_read_b64_tr_b16 a[132:133], v4 offset:320
    tbuffer_load_format_d16_xyzw v[58:59], v2, s[28:31], 0 format:[BUF_DATA_FORMAT_32_32_32_32,BUF_NUM_FORMAT_UINT] offen offset:1024 nt
    v_mfma_f32_16x16x32_bf16 a[4:7], a[116:119], v[68:71], a[4:7]
    v_exp_f32 v125, v125
    v_mfma_f32_16x16x32_bf16 a[0:3], a[112:115], v[68:71], a[0:3]
    s_waitcnt lgkmcnt(6)
    ds_read_b64_tr_b16 a[134:135], v4 offset:832
    v_cvt_pk_bf16_f32 v90, v124, v125
    v_mfma_f32_16x16x32_bf16 a[8:11], a[120:123], v[68:71], a[8:11]
    s_waitcnt lgkmcnt(5)
    v_exp_f32 v126, v126
    v_mfma_f32_16x16x32_bf16 a[12:15], a[124:127], v[68:71], a[12:15]
    s_waitcnt vmcnt(15)
    ds_read_b64_tr_b16 a[136:137], v4 offset:96
    ds_write_addtid_b32 v60 offset:58176
    v_mfma_f32_16x16x32_bf16 v[172:175], a[124:127], v[76:79], v[172:175]
    v_exp_f32 v127, v127
    v_mfma_f32_16x16x32_bf16 v[168:171], a[120:123], v[76:79], v[168:171]
    ds_read_b64_tr_b16 a[138:139], v4 offset:608
    v_cvt_pk_bf16_f32 v91, v126, v127
    v_mfma_f32_16x16x32_bf16 v[200:203], a[120:123], v[84:87], v[200:203]
    v_exp_f32 v112, v112
    v_mfma_f32_16x16x32_bf16 v[204:207], a[124:127], v[84:87], v[204:207]
    ds_read_b64_tr_b16 a[140:141], v4 offset:352
    ds_write_addtid_b32 v61 offset:58432
    v_mfma_f32_16x16x32_bf16 v[236:239], a[124:127], v[92:95], v[236:239]
    v_exp_f32 v113, v113
    v_mfma_f32_16x16x32_bf16 v[232:235], a[120:123], v[92:95], v[232:235]
    s_waitcnt lgkmcnt(7)
    ds_read_b64_tr_b16 a[142:143], v4 offset:864
    v_cvt_pk_bf16_f32 v80, v112, v113
    v_mfma_f32_16x16x32_bf16 v[240:243], a[128:131], v[92:95], v[240:243]
    s_waitcnt lgkmcnt(6)
    v_exp_f32 v114, v114
    v_mfma_f32_16x16x32_bf16 v[244:247], a[132:135], v[92:95], v[244:247]
    ds_read_b128 a[112:115], v3 offset:1024
    tbuffer_load_format_d16_xyzw v[60:61], v2, s[28:31], 0 format:[BUF_DATA_FORMAT_32_32_32_32,BUF_NUM_FORMAT_UINT] offen offset:2048 nt
    v_mfma_f32_16x16x32_bf16 v[212:215], a[132:135], v[84:87], v[212:215]
    v_exp_f32 v115, v115
    v_mfma_f32_16x16x32_bf16 v[208:211], a[128:131], v[84:87], v[208:211]
    ds_read_b128 v[16:19], v5 offset:144
    v_cvt_pk_bf16_f32 v81, v114, v115
    v_mfma_f32_16x16x32_bf16 v[176:179], a[128:131], v[76:79], v[176:179]
    v_exp_f32 v116, v116
    v_mfma_f32_16x16x32_bf16 v[180:183], a[132:135], v[76:79], v[180:183]
    s_waitcnt vmcnt(15)
    ds_read_b128 a[116:119], v3 offset:1536
    ds_write_addtid_b32 v62 offset:62304
    v_mfma_f32_16x16x32_bf16 a[20:23], a[132:135], v[68:71], a[20:23]
    v_exp_f32 v117, v117
    v_mfma_f32_16x16x32_bf16 a[16:19], a[128:131], v[68:71], a[16:19]
    s_waitcnt lgkmcnt(7)
    ds_write_addtid_b32 v63 offset:62560
    v_cvt_pk_bf16_f32 v82, v116, v117
    v_mfma_f32_16x16x32_bf16 a[24:27], a[136:139], v[68:71], a[24:27]
    s_waitcnt vmcnt(14) lgkmcnt(5)
    v_exp_f32 v118, v118
    v_pk_fma_f16 v32, v32, v20, v22
    v_mfma_f32_16x16x32_bf16 a[28:31], a[140:143], v[68:71], a[28:31]
    ds_read_b128 a[120:123], v3 offset:1280
    tbuffer_load_format_d16_xyzw v[62:63], v2, s[28:31], 0 format:[BUF_DATA_FORMAT_32_32_32_32,BUF_NUM_FORMAT_UINT] offen offset:3072 nt
    v_mfma_f32_16x16x32_bf16 v[188:191], a[140:143], v[76:79], v[188:191]
    v_exp_f32 v119, v119
    v_pk_fma_f16 v33, v33, v21, v23
    v_mfma_f32_16x16x32_bf16 v[184:187], a[136:139], v[76:79], v[184:187]
    ds_write_addtid_b32 v32 offset:16448
    v_cvt_pk_bf16_f32 v83, v118, v119
    v_mfma_f32_16x16x32_bf16 v[216:219], a[136:139], v[84:87], v[216:219]
    v_exp_f32 v104, v104
    v_mfma_f32_16x16x32_bf16 v[220:223], a[140:143], v[84:87], v[220:223]
    ds_read_b128 a[124:127], v3 offset:1792
    ds_write_addtid_b32 v33 offset:16704
    v_mfma_f32_16x16x32_bf16 v[252:255], a[140:143], v[92:95], v[252:255]
    s_waitcnt vmcnt(14)
    v_exp_f32 v105, v105
    v_pk_fma_f16 v34, v34, v20, v22
    v_mfma_f32_16x16x32_bf16 v[248:251], a[136:139], v[92:95], v[248:251]
    s_waitcnt lgkmcnt(8)
    tbuffer_load_format_d16_xyzw v[32:33], v1, s[24:27], 0 format:[BUF_DATA_FORMAT_32_32_32_32,BUF_NUM_FORMAT_UINT] offen nt
    v_cvt_pk_bf16_f32 v72, v104, v105
    v_mfma_f32_16x16x32_f16 v[152:155], a[112:115], a[96:99], v[12:15]
    s_waitcnt lgkmcnt(6)
    v_exp_f32 v106, v106
    v_pk_fma_f16 v35, v35, v21, v23
    v_mfma_f32_16x16x32_f16 v[156:159], a[116:119], a[96:99], v[16:19]
    ds_read_b128 a[128:131], v3 offset:1040
    ds_write_addtid_b32 v34 offset:20560
    v_mfma_f32_16x16x32_f16 v[148:151], a[116:119], a[80:83], v[16:19]
    v_exp_f32 v107, v107
    v_mfma_f32_16x16x32_f16 v[144:147], a[112:115], a[80:83], v[12:15]
    ds_write_addtid_b32 v35 offset:20816
    v_cvt_pk_bf16_f32 v73, v106, v107
    v_mfma_f32_16x16x32_f16 v[136:139], a[112:115], a[64:67], v[12:15]
    s_waitcnt vmcnt(14)
    v_exp_f32 v108, v108
    v_pk_fma_f16 v36, v36, v20, v22
    v_mfma_f32_16x16x32_f16 v[140:143], a[116:119], a[64:67], v[16:19]
    ds_read_b128 a[132:135], v3 offset:1552
    tbuffer_load_format_d16_xyzw v[34:35], v1, s[24:27], 0 format:[BUF_DATA_FORMAT_32_32_32_32,BUF_NUM_FORMAT_UINT] offen offset:1024 nt
    v_mfma_f32_16x16x32_f16 v[132:135], a[116:119], a[48:51], v[16:19]
    v_exp_f32 v109, v109
    v_pk_fma_f16 v37, v37, v21, v23
    v_mfma_f32_16x16x32_f16 v[128:131], a[112:115], a[48:51], v[12:15]
    s_waitcnt lgkmcnt(7)
    ds_write_addtid_b32 v36 offset:16960
    v_cvt_pk_bf16_f32 v74, v108, v109
    v_mfma_f32_16x16x32_f16 v[152:155], a[120:123], a[100:103], v[152:155]
    s_waitcnt lgkmcnt(6)
    v_exp_f32 v110, v110
    v_mfma_f32_16x16x32_f16 v[156:159], a[124:127], a[100:103], v[156:159]
    ds_read_b128 a[136:139], v3 offset:1296
    ds_write_addtid_b32 v37 offset:17216
    v_mfma_f32_16x16x32_f16 v[148:151], a[124:127], a[84:87], v[148:151]
    s_waitcnt vmcnt(14)
    v_exp_f32 v111, v111
    v_pk_fma_f16 v38, v38, v20, v22
    v_mfma_f32_16x16x32_f16 v[144:147], a[120:123], a[84:87], v[144:147]
    tbuffer_load_format_d16_xyzw v[36:37], v1, s[24:27], 0 format:[BUF_DATA_FORMAT_32_32_32_32,BUF_NUM_FORMAT_UINT] offen offset:2048 nt
    v_cvt_pk_bf16_f32 v75, v110, v111
    v_mfma_f32_16x16x32_f16 v[136:139], a[120:123], a[68:71], v[136:139]
    v_exp_f32 v96, v96
    v_mfma_f32_16x16x32_f16 v[140:143], a[124:127], a[68:71], v[140:143]
    ds_read_b128 a[140:143], v3 offset:1808
    ds_write_addtid_b32 v38 offset:21072
    v_mfma_f32_16x16x32_f16 v[132:135], a[124:127], a[52:55], v[132:135]
    v_exp_f32 v97, v97
    v_pk_fma_f16 v39, v39, v21, v23
    v_mfma_f32_16x16x32_f16 v[128:131], a[120:123], a[52:55], v[128:131]
    s_waitcnt lgkmcnt(8)
    ds_read_b64_tr_b16 a[112:113], v4 offset:1024
    v_cvt_pk_bf16_f32 v64, v96, v97
    v_mfma_f32_16x16x32_f16 v[152:155], a[128:131], a[104:107], v[152:155]
    s_waitcnt vmcnt(14) lgkmcnt(6)
    v_exp_f32 v98, v98
    v_pk_fma_f16 v40, v40, v20, v22
    v_mfma_f32_16x16x32_f16 v[156:159], a[132:135], a[104:107], v[156:159]
    ds_read_b64_tr_b16 a[114:115], v4 offset:1536
    ds_write_addtid_b32 v39 offset:21328
    v_mfma_f32_16x16x32_f16 v[148:151], a[132:135], a[88:91], v[148:151]
    v_exp_f32 v99, v99
    v_pk_fma_f16 v41, v41, v21, v23
    v_mfma_f32_16x16x32_f16 v[144:147], a[128:131], a[88:91], v[144:147]
    ds_read_b64_tr_b16 a[116:117], v4 offset:1280
    v_cvt_pk_bf16_f32 v65, v98, v99
    v_mfma_f32_16x16x32_f16 v[136:139], a[128:131], a[72:75], v[136:139]
    s_waitcnt vmcnt(13)
    v_exp_f32 v100, v100
    v_pk_fma_f16 v42, v42, v20, v22
    v_mfma_f32_16x16x32_f16 v[140:143], a[132:135], a[72:75], v[140:143]
    ds_read_b64_tr_b16 a[118:119], v4 offset:1792
    tbuffer_load_format_d16_xyzw v[38:39], v1, s[24:27], 0 format:[BUF_DATA_FORMAT_32_32_32_32,BUF_NUM_FORMAT_UINT] offen offset:3072 nt
    v_mfma_f32_16x16x32_f16 v[132:135], a[132:135], a[56:59], v[132:135]
    v_exp_f32 v101, v101
    v_pk_fma_f16 v43, v43, v21, v23
    v_mfma_f32_16x16x32_f16 v[128:131], a[128:131], a[56:59], v[128:131]
    s_waitcnt lgkmcnt(8)
    ds_read_b64_tr_b16 a[120:121], v4 offset:1056
    v_cvt_pk_bf16_f32 v66, v100, v101
    v_mfma_f32_16x16x32_f16 v[152:155], a[136:139], a[108:111], v[152:155]
    s_waitcnt vmcnt(13) lgkmcnt(7)
    v_exp_f32 v102, v102
    v_pk_fma_f16 v44, v44, v20, v22
    v_mfma_f32_16x16x32_f16 v[156:159], a[140:143], a[108:111], v[156:159]
    ds_read_b64_tr_b16 a[122:123], v4 offset:1568
    ds_write_addtid_b32 v40 offset:24672
    v_mfma_f32_16x16x32_f16 v[148:151], a[140:143], a[92:95], v[148:151]
    v_exp_f32 v103, v103
    v_pk_fma_f16 v45, v45, v21, v23
    v_mfma_f32_16x16x32_f16 v[144:147], a[136:139], a[92:95], v[144:147]
    ds_read_b64_tr_b16 a[124:125], v4 offset:1312
    v_cvt_pk_bf16_f32 v67, v102, v103
    v_mfma_f32_16x16x32_f16 v[136:139], a[136:139], a[76:79], v[136:139]
    ds_write_addtid_b32 v41 offset:24928
    tbuffer_load_format_d16_xyzw v[40:41], v2, s[24:27], 0 format:[BUF_DATA_FORMAT_32_32_32_32,BUF_NUM_FORMAT_UINT] offen nt
    v_mfma_f32_16x16x32_f16 v[140:143], a[140:143], a[76:79], v[140:143]
    ds_read_b64_tr_b16 a[126:127], v4 offset:1824
    ds_write_addtid_b32 v42 offset:28784
    v_mfma_f32_16x16x32_f16 v[132:135], a[140:143], a[60:63], v[132:135]
    ds_write_addtid_b32 v43 offset:29040
    tbuffer_load_format_d16_xyzw v[42:43], v2, s[24:27], 0 format:[BUF_DATA_FORMAT_32_32_32_32,BUF_NUM_FORMAT_UINT] offen offset:1024 nt
    v_mfma_f32_16x16x32_f16 v[128:131], a[136:139], a[60:63], v[128:131]
    s_waitcnt lgkmcnt(11)
    ds_read_b64_tr_b16 a[128:129], v4 offset:1088
    ds_write_addtid_b32 v44 offset:25184
    v_mfma_f32_16x16x32_bf16 v[224:227], a[112:115], v[88:91], v[224:227]
    s_waitcnt lgkmcnt(10)
    v_exp_f32 v152, v152
    v_mfma_f32_16x16x32_bf16 v[228:231], a[116:119], v[88:91], v[228:231]
    s_add_u32 s28, s28, 32768
    ds_read_b64_tr_b16 a[130:131], v4 offset:1600
    ds_write_addtid_b32 v45 offset:25440
    v_mfma_f32_16x16x32_bf16 v[196:199], a[116:119], v[80:83], v[196:199]
    s_addc_u32 s29, s29, 0
    v_exp_f32 v153, v153
    v_mfma_f32_16x16x32_bf16 v[192:195], a[112:115], v[80:83], v[192:195]
    ds_read_b64_tr_b16 a[132:133], v4 offset:1344
    v_cvt_pk_bf16_f32 v92, v152, v153
    v_mfma_f32_16x16x32_bf16 v[160:163], a[112:115], v[72:75], v[160:163]
    s_sub_u32 s30, s30, 32768
    v_exp_f32 v154, v154
    v_mfma_f32_16x16x32_bf16 v[164:167], a[116:119], v[72:75], v[164:167]
    ds_read_b64_tr_b16 a[134:135], v4 offset:1856
    tbuffer_load_format_d16_xyzw v[44:45], v2, s[24:27], 0 format:[BUF_DATA_FORMAT_32_32_32_32,BUF_NUM_FORMAT_UINT] offen offset:2048 nt
    v_mfma_f32_16x16x32_bf16 a[4:7], a[116:119], v[64:67], a[4:7]
    s_waitcnt vmcnt(15)
    v_exp_f32 v155, v155
    v_pk_fma_f16 v46, v46, v20, v22
    v_mfma_f32_16x16x32_bf16 a[0:3], a[112:115], v[64:67], a[0:3]
    s_waitcnt lgkmcnt(12)
    ds_read_b64_tr_b16 a[136:137], v4 offset:1120
    v_cvt_pk_bf16_f32 v93, v154, v155
    v_mfma_f32_16x16x32_bf16 a[8:11], a[120:123], v[64:67], a[8:11]
    s_waitcnt lgkmcnt(9)
    v_exp_f32 v156, v156
    v_mfma_f32_16x16x32_bf16 a[12:15], a[124:127], v[64:67], a[12:15]
    s_max_i32 s30, s30, 0
    ds_read_b64_tr_b16 a[138:139], v4 offset:1632
    ds_write_addtid_b32 v46 offset:29296
    v_mfma_f32_16x16x32_bf16 v[172:175], a[124:127], v[72:75], v[172:175]
    v_exp_f32 v157, v157
    v_pk_fma_f16 v47, v47, v21, v23
    v_mfma_f32_16x16x32_bf16 v[168:171], a[120:123], v[72:75], v[168:171]
    ds_read_b64_tr_b16 a[140:141], v4 offset:1376
    v_cvt_pk_bf16_f32 v94, v156, v157
    v_mfma_f32_16x16x32_bf16 v[200:203], a[120:123], v[80:83], v[200:203]
    v_exp_f32 v158, v158
    v_mfma_f32_16x16x32_bf16 v[204:207], a[124:127], v[80:83], v[204:207]
    ds_read_b64_tr_b16 a[142:143], v4 offset:1888
    ds_write_addtid_b32 v47 offset:29552
    v_mfma_f32_16x16x32_bf16 v[236:239], a[124:127], v[88:91], v[236:239]
    v_exp_f32 v159, v159
    v_mfma_f32_16x16x32_bf16 v[232:235], a[120:123], v[88:91], v[232:235]
    s_waitcnt lgkmcnt(9)
    ds_read_b128 v[12:15], v5 offset:256
    v_cvt_pk_bf16_f32 v95, v158, v159
    v_mfma_f32_16x16x32_bf16 v[240:243], a[128:131], v[88:91], v[240:243]
    v_exp_f32 v144, v144
    v_mfma_f32_16x16x32_bf16 v[208:211], a[128:131], v[80:83], v[208:211]
    ds_read_b128 v[16:19], v5 offset:272
    tbuffer_load_format_d16_xyzw v[46:47], v2, s[24:27], 0 format:[BUF_DATA_FORMAT_32_32_32_32,BUF_NUM_FORMAT_UINT] offen offset:3072 nt
    v_mfma_f32_16x16x32_bf16 v[176:179], a[128:131], v[72:75], v[176:179]
    s_waitcnt lgkmcnt(2)
    v_exp_f32 v145, v145
    v_mfma_f32_16x16x32_bf16 a[16:19], a[128:131], v[64:67], a[16:19]
    s_barrier
    v_cvt_pk_bf16_f32 v84, v144, v145
    v_mfma_f32_16x16x32_bf16 a[20:23], a[132:135], v[64:67], a[20:23]
    s_branch L_odd
L_tail:
    v_exp_f32 v146, v146
    v_mfma_f32_16x16x32_bf16 v[180:183], a[132:135], v[72:75], v[180:183]
    ds_read_b128 a[144:147], v6
    ds_read_b64_tr_b16 a[112:113], v4
    ds_read_b64_tr_b16 a[114:115], v4 offset:512
    v_mfma_f32_16x16x32_bf16 v[212:215], a[132:135], v[80:83], v[212:215]
    s_mov_b32 s70, 0x6e000000
    v_exp_f32 v147, v147
    v_mfma_f32_16x16x32_bf16 v[244:247], a[132:135], v[88:91], v[244:247]
    ds_read_b64_tr_b16 a[116:117], v4 offset:256
    ds_read_b64_tr_b16 a[118:119], v4 offset:768
    v_cvt_pk_bf16_f32 v85, v146, v147
    v_mfma_f32_16x16x32_bf16 a[24:27], a[136:139], v[64:67], a[24:27]
    ds_read_b64_tr_b16 a[120:121], v4 offset:32
    ds_read_b64_tr_b16 a[122:123], v4 offset:544
    v_exp_f32 v148, v148
    v_mfma_f32_16x16x32_bf16 a[28:31], a[140:143], v[64:67], a[28:31]
    ds_read_b64_tr_b16 a[124:125], v4 offset:288
    ds_read_b64_tr_b16 a[126:127], v4 offset:800
    v_mfma_f32_16x16x32_bf16 v[188:191], a[140:143], v[72:75], v[188:191]
    s_mov_b32 s71, 0x2b800000
    v_exp_f32 v149, v149
    v_mfma_f32_16x16x32_bf16 v[184:187], a[136:139], v[72:75], v[184:187]
    ds_read_b64_tr_b16 a[128:129], v4 offset:64
    ds_read_b64_tr_b16 a[130:131], v4 offset:576
    v_cvt_pk_bf16_f32 v86, v148, v149
    v_mfma_f32_16x16x32_bf16 v[216:219], a[136:139], v[80:83], v[216:219]
    ds_read_b64_tr_b16 a[132:133], v4 offset:320
    ds_read_b64_tr_b16 a[134:135], v4 offset:832
    v_exp_f32 v150, v150
    v_mfma_f32_16x16x32_bf16 v[220:223], a[140:143], v[80:83], v[220:223]
    v_mfma_f32_16x16x32_bf16 v[252:255], a[140:143], v[88:91], v[252:255]
    v_exp_f32 v151, v151
    v_mfma_f32_16x16x32_bf16 v[248:251], a[136:139], v[88:91], v[248:251]
    s_waitcnt vmcnt(10) lgkmcnt(12)
    ds_read_b64_tr_b16 a[136:137], v4 offset:96
    ds_read_b64_tr_b16 a[138:139], v4 offset:608
    v_cvt_pk_bf16_f32 v87, v150, v151
    v_bfe_u32 v59, v11, 4, 1
    v_smfmac_f32_16x16x64_bf16 a[44:47], a[144:147], v[88:95], v31
    s_waitcnt lgkmcnt(12)
    ds_read_b64_tr_b16 a[140:141], v4 offset:352
    ds_read_b64_tr_b16 a[142:143], v4 offset:864
    v_cvt_f32_u32 v59, v59
    v_mfma_f32_16x16x32_bf16 v[224:227], a[112:115], v[92:95], v[224:227]
    s_waitcnt vmcnt(8) lgkmcnt(12)
    v_and_b32 v63, 15, v11
    v_lshrrev_b32 v60, 4, v11
    v_and_b32 v61, 7, v11
    v_mfma_f32_16x16x32_bf16 v[228:231], a[116:119], v[92:95], v[228:231]
    s_waitcnt lgkmcnt(10)
    v_xor_b32 v60, v60, v61
    v_lshlrev_b32 v60, 4, v60
    v_lshl_add_u32 v60, v63, 8, v60
    v_mfma_f32_16x16x32_bf16 v[232:235], a[120:123], v[92:95], v[232:235]
    s_waitcnt lgkmcnt(8)
    v_add_u32 v60, s64, v60
    v_xor_b32 v61, 64, v60
    v_lshl_add_u32 v62, v11, 4, s64
    v_mfma_f32_16x16x32_bf16 v[236:239], a[124:127], v[92:95], v[236:239]
    s_waitcnt vmcnt(0) lgkmcnt(6)
    v_accvgpr_read_b32 v44, a44
    v_accvgpr_read_b32 v45, a45
    v_accvgpr_read_b32 v46, a46
    v_mfma_f32_16x16x32_bf16 v[240:243], a[128:131], v[92:95], v[240:243]
    s_waitcnt lgkmcnt(4)
    v_accvgpr_read_b32 v47, a47
    v_add_f32 v44, v44, v45
    v_mfma_f32_16x16x32_bf16 v[244:247], a[132:135], v[92:95], v[244:247]
    s_waitcnt lgkmcnt(2)
    v_add_f32 v47, v46, v47
    v_fma_f32 v45, v47, v59, v44
    v_fmac_f32 v44, v47, v59
    v_mfma_f32_16x16x32_bf16 v[248:251], a[136:139], v[92:95], v[248:251]
    s_waitcnt lgkmcnt(0)
    v_permlane16_swap_b32 v44, v45
    v_rcp_f32 v54, v45
    v_mfma_f32_16x16x32_bf16 v[252:255], a[140:143], v[92:95], v[252:255]
    v_mul_f32 v55, s71, v44
    v_mul_f32 v55, v55, v54
    v_mul_f32 v54, s70, v54
    v_pk_fma_f32 v[224:225], v[224:225], v[54:55], v[54:55] op_sel:[0,0,1] op_sel_hi:[1,0,1] neg_lo:[0,0,1] neg_hi:[0,0,1]
    v_pk_fma_f32 v[226:227], v[226:227], v[54:55], v[54:55] op_sel:[0,0,1] op_sel_hi:[1,0,1] neg_lo:[0,0,1] neg_hi:[0,0,1]
    v_pk_fma_f32 v[228:229], v[228:229], v[54:55], v[54:55] op_sel:[0,0,1] op_sel_hi:[1,0,1] neg_lo:[0,0,1] neg_hi:[0,0,1]
    v_pk_fma_f32 v[230:231], v[230:231], v[54:55], v[54:55] op_sel:[0,0,1] op_sel_hi:[1,0,1] neg_lo:[0,0,1] neg_hi:[0,0,1]
    v_pk_fma_f32 v[232:233], v[232:233], v[54:55], v[54:55] op_sel:[0,0,1] op_sel_hi:[1,0,1] neg_lo:[0,0,1] neg_hi:[0,0,1]
    v_pk_fma_f32 v[234:235], v[234:235], v[54:55], v[54:55] op_sel:[0,0,1] op_sel_hi:[1,0,1] neg_lo:[0,0,1] neg_hi:[0,0,1]
    v_pk_fma_f32 v[236:237], v[236:237], v[54:55], v[54:55] op_sel:[0,0,1] op_sel_hi:[1,0,1] neg_lo:[0,0,1] neg_hi:[0,0,1]
    v_pk_fma_f32 v[238:239], v[238:239], v[54:55], v[54:55] op_sel:[0,0,1] op_sel_hi:[1,0,1] neg_lo:[0,0,1] neg_hi:[0,0,1]
    v_pk_fma_f32 v[240:241], v[240:241], v[54:55], v[54:55] op_sel:[0,0,1] op_sel_hi:[1,0,1] neg_lo:[0,0,1] neg_hi:[0,0,1]
    v_pk_fma_f32 v[242:243], v[242:243], v[54:55], v[54:55] op_sel:[0,0,1] op_sel_hi:[1,0,1] neg_lo:[0,0,1] neg_hi:[0,0,1]
    v_pk_fma_f32 v[244:245], v[244:245], v[54:55], v[54:55] op_sel:[0,0,1] op_sel_hi:[1,0,1] neg_lo:[0,0,1] neg_hi:[0,0,1]
    v_pk_fma_f32 v[246:247], v[246:247], v[54:55], v[54:55] op_sel:[0,0,1] op_sel_hi:[1,0,1] neg_lo:[0,0,1] neg_hi:[0,0,1]
    v_pk_fma_f32 v[248:249], v[248:249], v[54:55], v[54:55] op_sel:[0,0,1] op_sel_hi:[1,0,1] neg_lo:[0,0,1] neg_hi:[0,0,1]
    v_pk_fma_f32 v[250:251], v[250:251], v[54:55], v[54:55] op_sel:[0,0,1] op_sel_hi:[1,0,1] neg_lo:[0,0,1] neg_hi:[0,0,1]
    v_pk_fma_f32 v[252:253], v[252:253], v[54:55], v[54:55] op_sel:[0,0,1] op_sel_hi:[1,0,1] neg_lo:[0,0,1] neg_hi:[0,0,1]
    v_pk_fma_f32 v[254:255], v[254:255], v[54:55], v[54:55] op_sel:[0,0,1] op_sel_hi:[1,0,1] neg_lo:[0,0,1] neg_hi:[0,0,1]
    v_smfmac_f32_16x16x64_bf16 a[40:43], a[144:147], v[80:87], v31
    v_cvt_pk_bf16_f32 v96, v224, v225
    v_cvt_pk_bf16_f32 v97, v228, v229
    v_cvt_pk_bf16_f32 v98, v226, v227
    v_cvt_pk_bf16_f32 v99, v230, v231
    v_mfma_f32_16x16x32_bf16 v[192:195], a[112:115], v[84:87], v[192:195]
    ds_write_b128 v60, v[96:99]
    v_mfma_f32_16x16x32_bf16 v[196:199], a[116:119], v[84:87], v[196:199]
    v_cvt_pk_bf16_f32 v100, v232, v233
    v_cvt_pk_bf16_f32 v101, v236, v237
    v_cvt_pk_bf16_f32 v102, v234, v235
    v_cvt_pk_bf16_f32 v103, v238, v239
    v_mfma_f32_16x16x32_bf16 v[200:203], a[120:123], v[84:87], v[200:203]
    ds_write_b128 v61, v[100:103]
    v_mfma_f32_16x16x32_bf16 v[204:207], a[124:127], v[84:87], v[204:207]
    v_cvt_pk_bf16_f32 v104, v240, v241
    v_cvt_pk_bf16_f32 v105, v244, v245
    v_cvt_pk_bf16_f32 v106, v242, v243
    v_cvt_pk_bf16_f32 v107, v246, v247
    v_mfma_f32_16x16x32_bf16 v[208:211], a[128:131], v[84:87], v[208:211]
    ds_write_b128 v60, v[104:107] offset:128
    v_mfma_f32_16x16x32_bf16 v[212:215], a[132:135], v[84:87], v[212:215]
    v_cvt_pk_bf16_f32 v108, v248, v249
    v_cvt_pk_bf16_f32 v109, v252, v253
    v_cvt_pk_bf16_f32 v110, v250, v251
    v_cvt_pk_bf16_f32 v111, v254, v255
    v_mfma_f32_16x16x32_bf16 v[216:219], a[136:139], v[84:87], v[216:219]
    ds_write_b128 v61, v[108:111] offset:128
    v_mfma_f32_16x16x32_bf16 v[220:223], a[140:143], v[84:87], v[220:223]
    ds_read_b128 v[112:115], v62
    ds_read_b128 v[116:119], v62 offset:1024
    ds_read_b128 v[120:123], v62 offset:2048
    ds_read_b128 v[124:127], v62 offset:3072
    v_accvgpr_read_b32 v40, a40
    v_accvgpr_read_b32 v41, a41
    v_accvgpr_read_b32 v42, a42
    v_accvgpr_read_b32 v43, a43
    v_add_f32 v40, v40, v41
    v_add_f32 v43, v42, v43
    v_fma_f32 v41, v43, v59, v40
    v_fmac_f32 v40, v43, v59
    s_nop 1
    v_permlane16_swap_b32 v40, v41
    v_rcp_f32 v52, v41
    v_mul_f32 v53, s71, v40
    v_mul_f32 v53, v53, v52
    s_waitcnt lgkmcnt(3)
    buffer_store_dwordx4 v[112:115], v9, s[32:35], s67 offen nt
    v_mul_f32 v52, s70, v52
    v_exp_f32 v136, v136
    v_exp_f32 v137, v137
    v_exp_f32 v138, v138
    v_exp_f32 v139, v139
    s_waitcnt lgkmcnt(2)
    buffer_store_dwordx4 v[116:119], v10, s[32:35], s67 offen offset:1024 nt
    v_cvt_pk_bf16_f32 v76, v136, v137
    v_exp_f32 v140, v140
    v_exp_f32 v141, v141
    v_cvt_pk_bf16_f32 v77, v138, v139
    v_exp_f32 v142, v142
    v_exp_f32 v143, v143
    s_waitcnt lgkmcnt(1)
    buffer_store_dwordx4 v[120:123], v9, s[32:35], s67 offen offset:2048 nt
    v_cvt_pk_bf16_f32 v78, v140, v141
    v_cvt_pk_bf16_f32 v79, v142, v143
    v_pk_fma_f32 v[192:193], v[192:193], v[52:53], v[52:53] op_sel:[0,0,1] op_sel_hi:[1,0,1] neg_lo:[0,0,1] neg_hi:[0,0,1]
    v_pk_fma_f32 v[194:195], v[194:195], v[52:53], v[52:53] op_sel:[0,0,1] op_sel_hi:[1,0,1] neg_lo:[0,0,1] neg_hi:[0,0,1]
    v_pk_fma_f32 v[196:197], v[196:197], v[52:53], v[52:53] op_sel:[0,0,1] op_sel_hi:[1,0,1] neg_lo:[0,0,1] neg_hi:[0,0,1]
    v_pk_fma_f32 v[198:199], v[198:199], v[52:53], v[52:53] op_sel:[0,0,1] op_sel_hi:[1,0,1] neg_lo:[0,0,1] neg_hi:[0,0,1]
    v_pk_fma_f32 v[200:201], v[200:201], v[52:53], v[52:53] op_sel:[0,0,1] op_sel_hi:[1,0,1] neg_lo:[0,0,1] neg_hi:[0,0,1]
    v_pk_fma_f32 v[202:203], v[202:203], v[52:53], v[52:53] op_sel:[0,0,1] op_sel_hi:[1,0,1] neg_lo:[0,0,1] neg_hi:[0,0,1]
    s_waitcnt lgkmcnt(0)
    buffer_store_dwordx4 v[124:127], v10, s[32:35], s67 offen offset:3072 nt
    v_pk_fma_f32 v[204:205], v[204:205], v[52:53], v[52:53] op_sel:[0,0,1] op_sel_hi:[1,0,1] neg_lo:[0,0,1] neg_hi:[0,0,1]
    v_pk_fma_f32 v[206:207], v[206:207], v[52:53], v[52:53] op_sel:[0,0,1] op_sel_hi:[1,0,1] neg_lo:[0,0,1] neg_hi:[0,0,1]
    v_pk_fma_f32 v[208:209], v[208:209], v[52:53], v[52:53] op_sel:[0,0,1] op_sel_hi:[1,0,1] neg_lo:[0,0,1] neg_hi:[0,0,1]
    v_pk_fma_f32 v[210:211], v[210:211], v[52:53], v[52:53] op_sel:[0,0,1] op_sel_hi:[1,0,1] neg_lo:[0,0,1] neg_hi:[0,0,1]
    v_pk_fma_f32 v[212:213], v[212:213], v[52:53], v[52:53] op_sel:[0,0,1] op_sel_hi:[1,0,1] neg_lo:[0,0,1] neg_hi:[0,0,1]
    v_pk_fma_f32 v[214:215], v[214:215], v[52:53], v[52:53] op_sel:[0,0,1] op_sel_hi:[1,0,1] neg_lo:[0,0,1] neg_hi:[0,0,1]
    v_pk_fma_f32 v[216:217], v[216:217], v[52:53], v[52:53] op_sel:[0,0,1] op_sel_hi:[1,0,1] neg_lo:[0,0,1] neg_hi:[0,0,1]
    v_pk_fma_f32 v[218:219], v[218:219], v[52:53], v[52:53] op_sel:[0,0,1] op_sel_hi:[1,0,1] neg_lo:[0,0,1] neg_hi:[0,0,1]
    v_pk_fma_f32 v[220:221], v[220:221], v[52:53], v[52:53] op_sel:[0,0,1] op_sel_hi:[1,0,1] neg_lo:[0,0,1] neg_hi:[0,0,1]
    v_pk_fma_f32 v[222:223], v[222:223], v[52:53], v[52:53] op_sel:[0,0,1] op_sel_hi:[1,0,1] neg_lo:[0,0,1] neg_hi:[0,0,1]
    v_smfmac_f32_16x16x64_bf16 a[36:39], a[144:147], v[72:79], v31
    v_cvt_pk_bf16_f32 v96, v192, v193
    v_cvt_pk_bf16_f32 v97, v196, v197
    v_cvt_pk_bf16_f32 v98, v194, v195
    v_cvt_pk_bf16_f32 v99, v198, v199
    v_mfma_f32_16x16x32_bf16 v[160:163], a[112:115], v[76:79], v[160:163]
    ds_write_b128 v60, v[96:99]
    v_mfma_f32_16x16x32_bf16 v[164:167], a[116:119], v[76:79], v[164:167]
    v_cvt_pk_bf16_f32 v100, v200, v201
    v_cvt_pk_bf16_f32 v101, v204, v205
    v_cvt_pk_bf16_f32 v102, v202, v203
    v_cvt_pk_bf16_f32 v103, v206, v207
    v_mfma_f32_16x16x32_bf16 v[168:171], a[120:123], v[76:79], v[168:171]
    ds_write_b128 v61, v[100:103]
    v_mfma_f32_16x16x32_bf16 v[172:175], a[124:127], v[76:79], v[172:175]
    v_cvt_pk_bf16_f32 v104, v208, v209
    v_cvt_pk_bf16_f32 v105, v212, v213
    v_cvt_pk_bf16_f32 v106, v210, v211
    v_cvt_pk_bf16_f32 v107, v214, v215
    v_mfma_f32_16x16x32_bf16 v[176:179], a[128:131], v[76:79], v[176:179]
    ds_write_b128 v60, v[104:107] offset:128
    v_mfma_f32_16x16x32_bf16 v[180:183], a[132:135], v[76:79], v[180:183]
    v_cvt_pk_bf16_f32 v108, v216, v217
    v_cvt_pk_bf16_f32 v109, v220, v221
    v_cvt_pk_bf16_f32 v110, v218, v219
    v_cvt_pk_bf16_f32 v111, v222, v223
    v_mfma_f32_16x16x32_bf16 v[184:187], a[136:139], v[76:79], v[184:187]
    ds_write_b128 v61, v[108:111] offset:128
    v_mfma_f32_16x16x32_bf16 v[188:191], a[140:143], v[76:79], v[188:191]
    ds_read_b128 v[112:115], v62
    ds_read_b128 v[116:119], v62 offset:1024
    ds_read_b128 v[120:123], v62 offset:2048
    ds_read_b128 v[124:127], v62 offset:3072
    v_accvgpr_read_b32 v36, a36
    v_accvgpr_read_b32 v37, a37
    v_accvgpr_read_b32 v38, a38
    v_accvgpr_read_b32 v39, a39
    v_add_f32 v36, v36, v37
    v_add_f32 v39, v38, v39
    v_fma_f32 v37, v39, v59, v36
    v_fmac_f32 v36, v39, v59
    s_nop 1
    v_permlane16_swap_b32 v36, v37
    v_rcp_f32 v50, v37
    v_mul_f32 v51, s71, v36
    v_mul_f32 v51, v51, v50
    s_waitcnt lgkmcnt(3)
    buffer_store_dwordx4 v[112:115], v9, s[32:35], s66 offen nt
    v_mul_f32 v50, s70, v50
    v_exp_f32 v128, v128
    v_exp_f32 v129, v129
    v_exp_f32 v130, v130
    v_exp_f32 v131, v131
    s_waitcnt lgkmcnt(2)
    buffer_store_dwordx4 v[116:119], v10, s[32:35], s66 offen offset:1024 nt
    v_cvt_pk_bf16_f32 v68, v128, v129
    v_exp_f32 v132, v132
    v_exp_f32 v133, v133
    v_cvt_pk_bf16_f32 v69, v130, v131
    v_exp_f32 v134, v134
    v_exp_f32 v135, v135
    s_waitcnt lgkmcnt(1)
    buffer_store_dwordx4 v[120:123], v9, s[32:35], s66 offen offset:2048 nt
    v_cvt_pk_bf16_f32 v70, v132, v133
    v_cvt_pk_bf16_f32 v71, v134, v135
    v_pk_fma_f32 v[160:161], v[160:161], v[50:51], v[50:51] op_sel:[0,0,1] op_sel_hi:[1,0,1] neg_lo:[0,0,1] neg_hi:[0,0,1]
    v_pk_fma_f32 v[162:163], v[162:163], v[50:51], v[50:51] op_sel:[0,0,1] op_sel_hi:[1,0,1] neg_lo:[0,0,1] neg_hi:[0,0,1]
    v_pk_fma_f32 v[164:165], v[164:165], v[50:51], v[50:51] op_sel:[0,0,1] op_sel_hi:[1,0,1] neg_lo:[0,0,1] neg_hi:[0,0,1]
    v_pk_fma_f32 v[166:167], v[166:167], v[50:51], v[50:51] op_sel:[0,0,1] op_sel_hi:[1,0,1] neg_lo:[0,0,1] neg_hi:[0,0,1]
    v_pk_fma_f32 v[168:169], v[168:169], v[50:51], v[50:51] op_sel:[0,0,1] op_sel_hi:[1,0,1] neg_lo:[0,0,1] neg_hi:[0,0,1]
    v_pk_fma_f32 v[170:171], v[170:171], v[50:51], v[50:51] op_sel:[0,0,1] op_sel_hi:[1,0,1] neg_lo:[0,0,1] neg_hi:[0,0,1]
    s_waitcnt lgkmcnt(0)
    buffer_store_dwordx4 v[124:127], v10, s[32:35], s66 offen offset:3072 nt
    v_pk_fma_f32 v[172:173], v[172:173], v[50:51], v[50:51] op_sel:[0,0,1] op_sel_hi:[1,0,1] neg_lo:[0,0,1] neg_hi:[0,0,1]
    v_pk_fma_f32 v[174:175], v[174:175], v[50:51], v[50:51] op_sel:[0,0,1] op_sel_hi:[1,0,1] neg_lo:[0,0,1] neg_hi:[0,0,1]
    v_pk_fma_f32 v[176:177], v[176:177], v[50:51], v[50:51] op_sel:[0,0,1] op_sel_hi:[1,0,1] neg_lo:[0,0,1] neg_hi:[0,0,1]
    v_pk_fma_f32 v[178:179], v[178:179], v[50:51], v[50:51] op_sel:[0,0,1] op_sel_hi:[1,0,1] neg_lo:[0,0,1] neg_hi:[0,0,1]
    v_pk_fma_f32 v[180:181], v[180:181], v[50:51], v[50:51] op_sel:[0,0,1] op_sel_hi:[1,0,1] neg_lo:[0,0,1] neg_hi:[0,0,1]
    v_pk_fma_f32 v[182:183], v[182:183], v[50:51], v[50:51] op_sel:[0,0,1] op_sel_hi:[1,0,1] neg_lo:[0,0,1] neg_hi:[0,0,1]
    v_pk_fma_f32 v[184:185], v[184:185], v[50:51], v[50:51] op_sel:[0,0,1] op_sel_hi:[1,0,1] neg_lo:[0,0,1] neg_hi:[0,0,1]
    v_pk_fma_f32 v[186:187], v[186:187], v[50:51], v[50:51] op_sel:[0,0,1] op_sel_hi:[1,0,1] neg_lo:[0,0,1] neg_hi:[0,0,1]
    v_pk_fma_f32 v[188:189], v[188:189], v[50:51], v[50:51] op_sel:[0,0,1] op_sel_hi:[1,0,1] neg_lo:[0,0,1] neg_hi:[0,0,1]
    v_pk_fma_f32 v[190:191], v[190:191], v[50:51], v[50:51] op_sel:[0,0,1] op_sel_hi:[1,0,1] neg_lo:[0,0,1] neg_hi:[0,0,1]
    v_smfmac_f32_16x16x64_bf16 a[32:35], a[144:147], v[64:71], v31
    v_cvt_pk_bf16_f32 v96, v160, v161
    v_cvt_pk_bf16_f32 v97, v164, v165
    v_cvt_pk_bf16_f32 v98, v162, v163
    v_cvt_pk_bf16_f32 v99, v166, v167
    v_mfma_f32_16x16x32_bf16 a[0:3], a[112:115], v[68:71], a[0:3]
    ds_write_b128 v60, v[96:99]
    v_mfma_f32_16x16x32_bf16 a[4:7], a[116:119], v[68:71], a[4:7]
    v_cvt_pk_bf16_f32 v100, v168, v169
    v_cvt_pk_bf16_f32 v101, v172, v173
    v_cvt_pk_bf16_f32 v102, v170, v171
    v_cvt_pk_bf16_f32 v103, v174, v175
    v_mfma_f32_16x16x32_bf16 a[8:11], a[120:123], v[68:71], a[8:11]
    ds_write_b128 v61, v[100:103]
    v_mfma_f32_16x16x32_bf16 a[12:15], a[124:127], v[68:71], a[12:15]
    v_cvt_pk_bf16_f32 v104, v176, v177
    v_cvt_pk_bf16_f32 v105, v180, v181
    v_cvt_pk_bf16_f32 v106, v178, v179
    v_cvt_pk_bf16_f32 v107, v182, v183
    v_mfma_f32_16x16x32_bf16 a[16:19], a[128:131], v[68:71], a[16:19]
    ds_write_b128 v60, v[104:107] offset:128
    v_mfma_f32_16x16x32_bf16 a[20:23], a[132:135], v[68:71], a[20:23]
    v_cvt_pk_bf16_f32 v108, v184, v185
    v_cvt_pk_bf16_f32 v109, v188, v189
    v_cvt_pk_bf16_f32 v110, v186, v187
    v_cvt_pk_bf16_f32 v111, v190, v191
    v_mfma_f32_16x16x32_bf16 a[24:27], a[136:139], v[68:71], a[24:27]
    ds_write_b128 v61, v[108:111] offset:128
    v_mfma_f32_16x16x32_bf16 a[28:31], a[140:143], v[68:71], a[28:31]
    ds_read_b128 v[112:115], v62
    ds_read_b128 v[116:119], v62 offset:1024
    ds_read_b128 v[120:123], v62 offset:2048
    ds_read_b128 v[124:127], v62 offset:3072
    v_accvgpr_read_b32 v32, a32
    v_accvgpr_read_b32 v33, a33
    v_accvgpr_read_b32 v34, a34
    v_accvgpr_read_b32 v35, a35
    v_add_f32 v32, v32, v33
    v_add_f32 v35, v34, v35
    v_fma_f32 v33, v35, v59, v32
    v_fmac_f32 v32, v35, v59
    s_nop 1
    v_permlane16_swap_b32 v32, v33
    v_rcp_f32 v48, v33
    v_mul_f32 v49, s71, v32
    v_mul_f32 v49, v49, v48
    s_waitcnt lgkmcnt(3)
    buffer_store_dwordx4 v[112:115], v9, s[32:35], s65 offen nt
    v_mul_f32 v48, s70, v48
    v_accvgpr_read_b32 v224, a0
    v_accvgpr_read_b32 v225, a1
    v_accvgpr_read_b32 v226, a2
    v_accvgpr_read_b32 v227, a3
    v_accvgpr_read_b32 v228, a4
    v_accvgpr_read_b32 v229, a5
    v_accvgpr_read_b32 v230, a6
    v_accvgpr_read_b32 v231, a7
    v_accvgpr_read_b32 v232, a8
    v_accvgpr_read_b32 v233, a9
    v_accvgpr_read_b32 v234, a10
    s_waitcnt lgkmcnt(2)
    buffer_store_dwordx4 v[116:119], v10, s[32:35], s65 offen offset:1024 nt
    v_accvgpr_read_b32 v235, a11
    v_accvgpr_read_b32 v236, a12
    v_accvgpr_read_b32 v237, a13
    v_accvgpr_read_b32 v238, a14
    v_accvgpr_read_b32 v239, a15
    v_accvgpr_read_b32 v240, a16
    v_accvgpr_read_b32 v241, a17
    v_accvgpr_read_b32 v242, a18
    v_accvgpr_read_b32 v243, a19
    v_accvgpr_read_b32 v244, a20
    v_accvgpr_read_b32 v245, a21
    v_accvgpr_read_b32 v246, a22
    s_waitcnt lgkmcnt(1)
    buffer_store_dwordx4 v[120:123], v9, s[32:35], s65 offen offset:2048 nt
    v_accvgpr_read_b32 v247, a23
    v_accvgpr_read_b32 v248, a24
    v_accvgpr_read_b32 v249, a25
    v_accvgpr_read_b32 v250, a26
    v_accvgpr_read_b32 v251, a27
    v_accvgpr_read_b32 v252, a28
    v_accvgpr_read_b32 v253, a29
    v_accvgpr_read_b32 v254, a30
    v_accvgpr_read_b32 v255, a31
    v_pk_fma_f32 v[224:225], v[224:225], v[48:49], v[48:49] op_sel:[0,0,1] op_sel_hi:[1,0,1] neg_lo:[0,0,1] neg_hi:[0,0,1]
    v_pk_fma_f32 v[226:227], v[226:227], v[48:49], v[48:49] op_sel:[0,0,1] op_sel_hi:[1,0,1] neg_lo:[0,0,1] neg_hi:[0,0,1]
    v_pk_fma_f32 v[228:229], v[228:229], v[48:49], v[48:49] op_sel:[0,0,1] op_sel_hi:[1,0,1] neg_lo:[0,0,1] neg_hi:[0,0,1]
    s_waitcnt lgkmcnt(0)
    buffer_store_dwordx4 v[124:127], v10, s[32:35], s65 offen offset:3072 nt
    v_pk_fma_f32 v[230:231], v[230:231], v[48:49], v[48:49] op_sel:[0,0,1] op_sel_hi:[1,0,1] neg_lo:[0,0,1] neg_hi:[0,0,1]
    v_pk_fma_f32 v[232:233], v[232:233], v[48:49], v[48:49] op_sel:[0,0,1] op_sel_hi:[1,0,1] neg_lo:[0,0,1] neg_hi:[0,0,1]
    v_pk_fma_f32 v[234:235], v[234:235], v[48:49], v[48:49] op_sel:[0,0,1] op_sel_hi:[1,0,1] neg_lo:[0,0,1] neg_hi:[0,0,1]
    v_pk_fma_f32 v[236:237], v[236:237], v[48:49], v[48:49] op_sel:[0,0,1] op_sel_hi:[1,0,1] neg_lo:[0,0,1] neg_hi:[0,0,1]
    v_pk_fma_f32 v[238:239], v[238:239], v[48:49], v[48:49] op_sel:[0,0,1] op_sel_hi:[1,0,1] neg_lo:[0,0,1] neg_hi:[0,0,1]
    v_pk_fma_f32 v[240:241], v[240:241], v[48:49], v[48:49] op_sel:[0,0,1] op_sel_hi:[1,0,1] neg_lo:[0,0,1] neg_hi:[0,0,1]
    v_pk_fma_f32 v[242:243], v[242:243], v[48:49], v[48:49] op_sel:[0,0,1] op_sel_hi:[1,0,1] neg_lo:[0,0,1] neg_hi:[0,0,1]
    v_pk_fma_f32 v[244:245], v[244:245], v[48:49], v[48:49] op_sel:[0,0,1] op_sel_hi:[1,0,1] neg_lo:[0,0,1] neg_hi:[0,0,1]
    v_pk_fma_f32 v[246:247], v[246:247], v[48:49], v[48:49] op_sel:[0,0,1] op_sel_hi:[1,0,1] neg_lo:[0,0,1] neg_hi:[0,0,1]
    v_pk_fma_f32 v[248:249], v[248:249], v[48:49], v[48:49] op_sel:[0,0,1] op_sel_hi:[1,0,1] neg_lo:[0,0,1] neg_hi:[0,0,1]
    v_pk_fma_f32 v[250:251], v[250:251], v[48:49], v[48:49] op_sel:[0,0,1] op_sel_hi:[1,0,1] neg_lo:[0,0,1] neg_hi:[0,0,1]
    v_pk_fma_f32 v[252:253], v[252:253], v[48:49], v[48:49] op_sel:[0,0,1] op_sel_hi:[1,0,1] neg_lo:[0,0,1] neg_hi:[0,0,1]
    v_pk_fma_f32 v[254:255], v[254:255], v[48:49], v[48:49] op_sel:[0,0,1] op_sel_hi:[1,0,1] neg_lo:[0,0,1] neg_hi:[0,0,1]
    v_cvt_pk_bf16_f32 v96, v224, v225
    v_cvt_pk_bf16_f32 v97, v228, v229
    v_cvt_pk_bf16_f32 v98, v226, v227
    v_cvt_pk_bf16_f32 v99, v230, v231
    ds_write_b128 v60, v[96:99]
    v_cvt_pk_bf16_f32 v100, v232, v233
    v_cvt_pk_bf16_f32 v101, v236, v237
    v_cvt_pk_bf16_f32 v102, v234, v235
    v_cvt_pk_bf16_f32 v103, v238, v239
    ds_write_b128 v61, v[100:103]
    v_cvt_pk_bf16_f32 v104, v240, v241
    v_cvt_pk_bf16_f32 v105, v244, v245
    v_cvt_pk_bf16_f32 v106, v242, v243
    v_cvt_pk_bf16_f32 v107, v246, v247
    ds_write_b128 v60, v[104:107] offset:128
    v_cvt_pk_bf16_f32 v108, v248, v249
    v_cvt_pk_bf16_f32 v109, v252, v253
    v_cvt_pk_bf16_f32 v110, v250, v251
    v_cvt_pk_bf16_f32 v111, v254, v255
    ds_write_b128 v61, v[108:111] offset:128
    ds_read_b128 v[112:115], v62
    ds_read_b128 v[116:119], v62 offset:1024
    ds_read_b128 v[120:123], v62 offset:2048
    ds_read_b128 v[124:127], v62 offset:3072
    s_waitcnt lgkmcnt(3)
    buffer_store_dwordx4 v[112:115], v9, s[32:35], s56 offen nt
    s_waitcnt lgkmcnt(2)
    buffer_store_dwordx4 v[116:119], v10, s[32:35], s56 offen offset:1024 nt
    s_waitcnt lgkmcnt(1)
    buffer_store_dwordx4 v[120:123], v9, s[32:35], s56 offen offset:2048 nt
    s_waitcnt lgkmcnt(0)
    buffer_store_dwordx4 v[124:127], v10, s[32:35], s56 offen offset:3072 nt
    v_maximum3_f32 v48, v160, v161, v162
    v_maximum3_f32 v48, v48, v163, v164
    v_maximum3_f32 v48, v48, v165, v166
    v_maximum3_f32 v48, v48, v167, v168
    v_maximum3_f32 v48, v48, v169, v170
    v_maximum3_f32 v48, v48, v171, v172
    v_maximum3_f32 v48, v48, v173, v174
    v_maximum3_f32 v48, v48, v175, v176
    v_maximum3_f32 v48, v48, v177, v178
    v_maximum3_f32 v48, v48, v179, v180
    v_maximum3_f32 v48, v48, v181, v182
    v_maximum3_f32 v48, v48, v183, v184
    v_maximum3_f32 v48, v48, v185, v186
    v_maximum3_f32 v48, v48, v187, v188
    v_maximum3_f32 v48, v48, v189, v190
    v_cmp_u_f32 vcc, v48, v191
    s_nop 0
    s_or_b32 s61, vcc_lo, vcc_hi
    v_min3_u32 v56, v35, v39, v43
    v_max3_u32 v57, v35, v39, v43
    v_and_b32 v32, 0x7fffffff, v32
    v_and_b32 v36, 0x7fffffff, v36
    v_and_b32 v40, 0x7fffffff, v40
    v_and_b32 v44, 0x7fffffff, v44
    v_max3_u32 v58, v32, v33, v36
    v_min_u32 v56, v56, v47
    v_max_u32 v57, v57, v47
    v_max3_u32 v58, v58, v37, v40
    v_max3_u32 v58, v58, v41, v44
    v_max_u32 v58, v58, v45
    v_cmp_gt_u32 vcc, 0x58800000, v56
    s_nop 0
    s_mov_b64 s[68:69], vcc
    v_cmp_lt_u32 vcc, 0x7b000000, v57
    s_nop 0
    s_or_b64 s[68:69], s[68:69], vcc
    v_cmp_lt_u32 vcc, 0x7e800000, v58
    s_nop 0
    s_or_b64 s[68:69], s[68:69], vcc
    s_and_b32 s68, s68, 0xffff
    s_or_b32 s68, s68, s61
    s_cbranch_scc1 L_slow
L_end:
    s_endpgm
L_slow:
    s_waitcnt vmcnt(0) lgkmcnt(0)
    s_mov_b32 s70, 0x3e0293ee
    s_mov_b32 s72, 0xffff0000
    s_lshl_b32 s62, s59, 20
    s_add_u32 s24, s6, s62
    s_addc_u32 s25, s7, 0
    s_mov_b32 s26, 0x100000
    s_add_u32 s28, s8, s62
    s_addc_u32 s29, s9, 0
    s_mov_b32 s30, 0x100000
    v_and_b32 v10, 15, v11
    v_lshrrev_b32 v12, 4, v11
    s_lshl_b32 s62, s58, 14
    v_lshlrev_b32 v1, 8, v10
    v_add_u32 v1, s62, v1
    v_lshl_add_u32 v6, v12, 6, v1
    v_lshl_add_u32 v1, v12, 4, v1
    v_lshrrev_b32 v2, 2, v10
    v_lshlrev_b32 v2, 3, v2
    v_and_b32 v3, 3, v10
    v_add_u32 v2, v2, v3
    v_lshlrev_b32 v2, 9, v2
    v_lshl_add_u32 v2, v12, 5, v2
    v_lshlrev_b32 v3, 4, v12
    v_lshlrev_b32 v4, 12, v12
    v_lshl_add_u32 v4, v10, 5, v4
    s_mov_b32 s52, 0
L_slow_q:
    buffer_load_dwordx4 v[16:19], v1, s[20:23], s52 offen
    buffer_load_dwordx4 v[20:23], v1, s[20:23], s52 offen offset:64
    buffer_load_dwordx4 v[24:27], v1, s[20:23], s52 offen offset:128
    buffer_load_dwordx4 v[28:31], v1, s[20:23], s52 offen offset:192
    v_mov_b32 v7, 0xff800000
    v_mov_b32 v8, 0
    v_mov_b32 v160, 0
    v_mov_b32 v161, 0
    v_mov_b32 v162, 0
    v_mov_b32 v163, 0
    v_mov_b32 v164, 0
    v_mov_b32 v165, 0
    v_mov_b32 v166, 0
    v_mov_b32 v167, 0
    v_mov_b32 v168, 0
    v_mov_b32 v169, 0
    v_mov_b32 v170, 0
    v_mov_b32 v171, 0
    v_mov_b32 v172, 0
    v_mov_b32 v173, 0
    v_mov_b32 v174, 0
    v_mov_b32 v175, 0
    v_mov_b32 v176, 0
    v_mov_b32 v177, 0
    v_mov_b32 v178, 0
    v_mov_b32 v179, 0
    v_mov_b32 v180, 0
    v_mov_b32 v181, 0
    v_mov_b32 v182, 0
    v_mov_b32 v183, 0
    v_mov_b32 v184, 0
    v_mov_b32 v185, 0
    v_mov_b32 v186, 0
    v_mov_b32 v187, 0
    v_mov_b32 v188, 0
    v_mov_b32 v189, 0
    v_mov_b32 v190, 0
    v_mov_b32 v191, 0
    s_mov_b32 s53, 0
    s_waitcnt vmcnt(0)
L_slow_s:
    s_lshl_b32 s54, s53, 14
    s_lshr_b32 s55, s53, 1
    s_lshl_b32 s55, s55, 8
    s_lshl_b32 s61, s53, 6
    buffer_load_dwordx4 v[192:195], v3, s[36:39], s55 offen
    buffer_load_dwordx4 v[196:199], v3, s[40:43], s55 offen
    buffer_load_dwordx4 v[48:51], v2, s[24:27], s54 offen
    buffer_load_dwordx4 v[52:55], v2, s[24:27], s54 offen offset:16
    buffer_load_dwordx4 v[56:59], v2, s[24:27], s54 offen offset:2048
    buffer_load_dwordx4 v[60:63], v2, s[24:27], s54 offen offset:2064
    s_waitcnt vmcnt(5)
    v_lshlrev_b32 v32, 16, v192
    v_and_b32 v33, s72, v192
    v_lshlrev_b32 v34, 16, v193
    v_and_b32 v35, s72, v193
    v_lshlrev_b32 v36, 16, v194
    v_and_b32 v37, s72, v194
    v_lshlrev_b32 v38, 16, v195
    v_and_b32 v39, s72, v195
    s_waitcnt vmcnt(4)
    v_lshlrev_b32 v40, 16, v196
    v_and_b32 v41, s72, v196
    v_lshlrev_b32 v42, 16, v197
    v_and_b32 v43, s72, v197
    v_lshlrev_b32 v44, 16, v198
    v_and_b32 v45, s72, v198
    v_lshlrev_b32 v46, 16, v199
    v_and_b32 v47, s72, v199
    s_waitcnt vmcnt(3)
    v_cvt_f32_i32 v48, v48
    v_cvt_f32_i32 v49, v49
    v_cvt_pk_bf16_f32 v112, v48, v49
    v_lshlrev_b32 v48, 16, v112
    v_and_b32 v49, s72, v112
    v_sub_f32 v48, v48, v40
    v_sub_f32 v49, v49, v41
    v_cvt_pk_bf16_f32 v112, v48, v49
    v_lshlrev_b32 v48, 16, v112
    v_and_b32 v49, s72, v112
    v_mul_f32 v48, v48, v32
    v_mul_f32 v49, v49, v33
    v_cvt_pk_bf16_f32 v112, v48, v49
    v_cvt_f32_i32 v50, v50
    v_cvt_f32_i32 v51, v51
    v_cvt_pk_bf16_f32 v113, v50, v51
    v_lshlrev_b32 v50, 16, v113
    v_and_b32 v51, s72, v113
    v_sub_f32 v50, v50, v42
    v_sub_f32 v51, v51, v43
    v_cvt_pk_bf16_f32 v113, v50, v51
    v_lshlrev_b32 v50, 16, v113
    v_and_b32 v51, s72, v113
    v_mul_f32 v50, v50, v34
    v_mul_f32 v51, v51, v35
    v_cvt_pk_bf16_f32 v113, v50, v51
    s_waitcnt vmcnt(2)
    v_cvt_f32_i32 v52, v52
    v_cvt_f32_i32 v53, v53
    v_cvt_pk_bf16_f32 v114, v52, v53
    v_lshlrev_b32 v52, 16, v114
    v_and_b32 v53, s72, v114
    v_sub_f32 v52, v52, v44
    v_sub_f32 v53, v53, v45
    v_cvt_pk_bf16_f32 v114, v52, v53
    v_lshlrev_b32 v52, 16, v114
    v_and_b32 v53, s72, v114
    v_mul_f32 v52, v52, v36
    v_mul_f32 v53, v53, v37
    v_cvt_pk_bf16_f32 v114, v52, v53
    v_cvt_f32_i32 v54, v54
    v_cvt_f32_i32 v55, v55
    v_cvt_pk_bf16_f32 v115, v54, v55
    v_lshlrev_b32 v54, 16, v115
    v_and_b32 v55, s72, v115
    v_sub_f32 v54, v54, v46
    v_sub_f32 v55, v55, v47
    v_cvt_pk_bf16_f32 v115, v54, v55
    v_lshlrev_b32 v54, 16, v115
    v_and_b32 v55, s72, v115
    v_mul_f32 v54, v54, v38
    v_mul_f32 v55, v55, v39
    v_cvt_pk_bf16_f32 v115, v54, v55
    s_waitcnt vmcnt(1)
    v_cvt_f32_i32 v56, v56
    v_cvt_f32_i32 v57, v57
    v_cvt_pk_bf16_f32 v116, v56, v57
    v_lshlrev_b32 v56, 16, v116
    v_and_b32 v57, s72, v116
    v_sub_f32 v56, v56, v40
    v_sub_f32 v57, v57, v41
    v_cvt_pk_bf16_f32 v116, v56, v57
    v_lshlrev_b32 v56, 16, v116
    v_and_b32 v57, s72, v116
    v_mul_f32 v56, v56, v32
    v_mul_f32 v57, v57, v33
    v_cvt_pk_bf16_f32 v116, v56, v57
    v_cvt_f32_i32 v58, v58
    v_cvt_f32_i32 v59, v59
    v_cvt_pk_bf16_f32 v117, v58, v59
    v_lshlrev_b32 v58, 16, v117
    v_and_b32 v59, s72, v117
    v_sub_f32 v58, v58, v42
    v_sub_f32 v59, v59, v43
    v_cvt_pk_bf16_f32 v117, v58, v59
    v_lshlrev_b32 v58, 16, v117
    v_and_b32 v59, s72, v117
    v_mul_f32 v58, v58, v34
    v_mul_f32 v59, v59, v35
    v_cvt_pk_bf16_f32 v117, v58, v59
    s_waitcnt vmcnt(0)
    v_cvt_f32_i32 v60, v60
    v_cvt_f32_i32 v61, v61
    v_cvt_pk_bf16_f32 v118, v60, v61
    v_lshlrev_b32 v60, 16, v118
    v_and_b32 v61, s72, v118
    v_sub_f32 v60, v60, v44
    v_sub_f32 v61, v61, v45
    v_cvt_pk_bf16_f32 v118, v60, v61
    v_lshlrev_b32 v60, 16, v118
    v_and_b32 v61, s72, v118
    v_mul_f32 v60, v60, v36
    v_mul_f32 v61, v61, v37
    v_cvt_pk_bf16_f32 v118, v60, v61
    v_cvt_f32_i32 v62, v62
    v_cvt_f32_i32 v63, v63
    v_cvt_pk_bf16_f32 v119, v62, v63
    v_lshlrev_b32 v62, 16, v119
    v_and_b32 v63, s72, v119
    v_sub_f32 v62, v62, v46
    v_sub_f32 v63, v63, v47
    v_cvt_pk_bf16_f32 v119, v62, v63
    v_lshlrev_b32 v62, 16, v119
    v_and_b32 v63, s72, v119
    v_mul_f32 v62, v62, v38
    v_mul_f32 v63, v63, v39
    v_cvt_pk_bf16_f32 v119, v62, v63
    v_mfma_f32_16x16x32_bf16 v[144:147], v[112:115], v[16:19], 0
    s_nop 0
    v_mfma_f32_16x16x32_bf16 v[148:151], v[116:119], v[16:19], 0
    buffer_load_dwordx4 v[192:195], v3, s[36:39], s55 offen offset:64
    buffer_load_dwordx4 v[196:199], v3, s[40:43], s55 offen offset:64
    buffer_load_dwordx4 v[48:51], v2, s[24:27], s54 offen offset:128
    buffer_load_dwordx4 v[52:55], v2, s[24:27], s54 offen offset:144
    buffer_load_dwordx4 v[56:59], v2, s[24:27], s54 offen offset:2176
    buffer_load_dwordx4 v[60:63], v2, s[24:27], s54 offen offset:2192
    s_waitcnt vmcnt(5)
    v_lshlrev_b32 v32, 16, v192
    v_and_b32 v33, s72, v192
    v_lshlrev_b32 v34, 16, v193
    v_and_b32 v35, s72, v193
    v_lshlrev_b32 v36, 16, v194
    v_and_b32 v37, s72, v194
    v_lshlrev_b32 v38, 16, v195
    v_and_b32 v39, s72, v195
    s_waitcnt vmcnt(4)
    v_lshlrev_b32 v40, 16, v196
    v_and_b32 v41, s72, v196
    v_lshlrev_b32 v42, 16, v197
    v_and_b32 v43, s72, v197
    v_lshlrev_b32 v44, 16, v198
    v_and_b32 v45, s72, v198
    v_lshlrev_b32 v46, 16, v199
    v_and_b32 v47, s72, v199
    s_waitcnt vmcnt(3)
    v_cvt_f32_i32 v48, v48
    v_cvt_f32_i32 v49, v49
    v_cvt_pk_bf16_f32 v112, v48, v49
    v_lshlrev_b32 v48, 16, v112
    v_and_b32 v49, s72, v112
    v_sub_f32 v48, v48, v40
    v_sub_f32 v49, v49, v41
    v_cvt_pk_bf16_f32 v112, v48, v49
    v_lshlrev_b32 v48, 16, v112
    v_and_b32 v49, s72, v112
    v_mul_f32 v48, v48, v32
    v_mul_f32 v49, v49, v33
    v_cvt_pk_bf16_f32 v112, v48, v49
    v_cvt_f32_i32 v50, v50
    v_cvt_f32_i32 v51, v51
    v_cvt_pk_bf16_f32 v113, v50, v51
    v_lshlrev_b32 v50, 16, v113
    v_and_b32 v51, s72, v113
    v_sub_f32 v50, v50, v42
    v_sub_f32 v51, v51, v43
    v_cvt_pk_bf16_f32 v113, v50, v51
    v_lshlrev_b32 v50, 16, v113
    v_and_b32 v51, s72, v113
    v_mul_f32 v50, v50, v34
    v_mul_f32 v51, v51, v35
    v_cvt_pk_bf16_f32 v113, v50, v51
    s_waitcnt vmcnt(2)
    v_cvt_f32_i32 v52, v52
    v_cvt_f32_i32 v53, v53
    v_cvt_pk_bf16_f32 v114, v52, v53
    v_lshlrev_b32 v52, 16, v114
    v_and_b32 v53, s72, v114
    v_sub_f32 v52, v52, v44
    v_sub_f32 v53, v53, v45
    v_cvt_pk_bf16_f32 v114, v52, v53
    v_lshlrev_b32 v52, 16, v114
    v_and_b32 v53, s72, v114
    v_mul_f32 v52, v52, v36
    v_mul_f32 v53, v53, v37
    v_cvt_pk_bf16_f32 v114, v52, v53
    v_cvt_f32_i32 v54, v54
    v_cvt_f32_i32 v55, v55
    v_cvt_pk_bf16_f32 v115, v54, v55
    v_lshlrev_b32 v54, 16, v115
    v_and_b32 v55, s72, v115
    v_sub_f32 v54, v54, v46
    v_sub_f32 v55, v55, v47
    v_cvt_pk_bf16_f32 v115, v54, v55
    v_lshlrev_b32 v54, 16, v115
    v_and_b32 v55, s72, v115
    v_mul_f32 v54, v54, v38
    v_mul_f32 v55, v55, v39
    v_cvt_pk_bf16_f32 v115, v54, v55
    s_waitcnt vmcnt(1)
    v_cvt_f32_i32 v56, v56
    v_cvt_f32_i32 v57, v57
    v_cvt_pk_bf16_f32 v116, v56, v57
    v_lshlrev_b32 v56, 16, v116
    v_and_b32 v57, s72, v116
    v_sub_f32 v56, v56, v40
    v_sub_f32 v57, v57, v41
    v_cvt_pk_bf16_f32 v116, v56, v57
    v_lshlrev_b32 v56, 16, v116
    v_and_b32 v57, s72, v116
    v_mul_f32 v56, v56, v32
    v_mul_f32 v57, v57, v33
    v_cvt_pk_bf16_f32 v116, v56, v57
    v_cvt_f32_i32 v58, v58
    v_cvt_f32_i32 v59, v59
    v_cvt_pk_bf16_f32 v117, v58, v59
    v_lshlrev_b32 v58, 16, v117
    v_and_b32 v59, s72, v117
    v_sub_f32 v58, v58, v42
    v_sub_f32 v59, v59, v43
    v_cvt_pk_bf16_f32 v117, v58, v59
    v_lshlrev_b32 v58, 16, v117
    v_and_b32 v59, s72, v117
    v_mul_f32 v58, v58, v34
    v_mul_f32 v59, v59, v35
    v_cvt_pk_bf16_f32 v117, v58, v59
    s_waitcnt vmcnt(0)
    v_cvt_f32_i32 v60, v60
    v_cvt_f32_i32 v61, v61
    v_cvt_pk_bf16_f32 v118, v60, v61
    v_lshlrev_b32 v60, 16, v118
    v_and_b32 v61, s72, v118
    v_sub_f32 v60, v60, v44
    v_sub_f32 v61, v61, v45
    v_cvt_pk_bf16_f32 v118, v60, v61
    v_lshlrev_b32 v60, 16, v118
    v_and_b32 v61, s72, v118
    v_mul_f32 v60, v60, v36
    v_mul_f32 v61, v61, v37
    v_cvt_pk_bf16_f32 v118, v60, v61
    v_cvt_f32_i32 v62, v62
    v_cvt_f32_i32 v63, v63
    v_cvt_pk_bf16_f32 v119, v62, v63
    v_lshlrev_b32 v62, 16, v119
    v_and_b32 v63, s72, v119
    v_sub_f32 v62, v62, v46
    v_sub_f32 v63, v63, v47
    v_cvt_pk_bf16_f32 v119, v62, v63
    v_lshlrev_b32 v62, 16, v119
    v_and_b32 v63, s72, v119
    v_mul_f32 v62, v62, v38
    v_mul_f32 v63, v63, v39
    v_cvt_pk_bf16_f32 v119, v62, v63
    v_mfma_f32_16x16x32_bf16 v[144:147], v[112:115], v[20:23], v[144:147]
    s_nop 0
    v_mfma_f32_16x16x32_bf16 v[148:151], v[116:119], v[20:23], v[148:151]
    buffer_load_dwordx4 v[192:195], v3, s[36:39], s55 offen offset:128
    buffer_load_dwordx4 v[196:199], v3, s[40:43], s55 offen offset:128
    buffer_load_dwordx4 v[48:51], v2, s[24:27], s54 offen offset:256
    buffer_load_dwordx4 v[52:55], v2, s[24:27], s54 offen offset:272
    buffer_load_dwordx4 v[56:59], v2, s[24:27], s54 offen offset:2304
    buffer_load_dwordx4 v[60:63], v2, s[24:27], s54 offen offset:2320
    s_waitcnt vmcnt(5)
    v_lshlrev_b32 v32, 16, v192
    v_and_b32 v33, s72, v192
    v_lshlrev_b32 v34, 16, v193
    v_and_b32 v35, s72, v193
    v_lshlrev_b32 v36, 16, v194
    v_and_b32 v37, s72, v194
    v_lshlrev_b32 v38, 16, v195
    v_and_b32 v39, s72, v195
    s_waitcnt vmcnt(4)
    v_lshlrev_b32 v40, 16, v196
    v_and_b32 v41, s72, v196
    v_lshlrev_b32 v42, 16, v197
    v_and_b32 v43, s72, v197
    v_lshlrev_b32 v44, 16, v198
    v_and_b32 v45, s72, v198
    v_lshlrev_b32 v46, 16, v199
    v_and_b32 v47, s72, v199
    s_waitcnt vmcnt(3)
    v_cvt_f32_i32 v48, v48
    v_cvt_f32_i32 v49, v49
    v_cvt_pk_bf16_f32 v112, v48, v49
    v_lshlrev_b32 v48, 16, v112
    v_and_b32 v49, s72, v112
    v_sub_f32 v48, v48, v40
    v_sub_f32 v49, v49, v41
    v_cvt_pk_bf16_f32 v112, v48, v49
    v_lshlrev_b32 v48, 16, v112
    v_and_b32 v49, s72, v112
    v_mul_f32 v48, v48, v32
    v_mul_f32 v49, v49, v33
    v_cvt_pk_bf16_f32 v112, v48, v49
    v_cvt_f32_i32 v50, v50
    v_cvt_f32_i32 v51, v51
    v_cvt_pk_bf16_f32 v113, v50, v51
    v_lshlrev_b32 v50, 16, v113
    v_and_b32 v51, s72, v113
    v_sub_f32 v50, v50, v42
    v_sub_f32 v51, v51, v43
    v_cvt_pk_bf16_f32 v113, v50, v51
    v_lshlrev_b32 v50, 16, v113
    v_and_b32 v51, s72, v113
    v_mul_f32 v50, v50, v34
    v_mul_f32 v51, v51, v35
    v_cvt_pk_bf16_f32 v113, v50, v51
    s_waitcnt vmcnt(2)
    v_cvt_f32_i32 v52, v52
    v_cvt_f32_i32 v53, v53
    v_cvt_pk_bf16_f32 v114, v52, v53
    v_lshlrev_b32 v52, 16, v114
    v_and_b32 v53, s72, v114
    v_sub_f32 v52, v52, v44
    v_sub_f32 v53, v53, v45
    v_cvt_pk_bf16_f32 v114, v52, v53
    v_lshlrev_b32 v52, 16, v114
    v_and_b32 v53, s72, v114
    v_mul_f32 v52, v52, v36
    v_mul_f32 v53, v53, v37
    v_cvt_pk_bf16_f32 v114, v52, v53
    v_cvt_f32_i32 v54, v54
    v_cvt_f32_i32 v55, v55
    v_cvt_pk_bf16_f32 v115, v54, v55
    v_lshlrev_b32 v54, 16, v115
    v_and_b32 v55, s72, v115
    v_sub_f32 v54, v54, v46
    v_sub_f32 v55, v55, v47
    v_cvt_pk_bf16_f32 v115, v54, v55
    v_lshlrev_b32 v54, 16, v115
    v_and_b32 v55, s72, v115
    v_mul_f32 v54, v54, v38
    v_mul_f32 v55, v55, v39
    v_cvt_pk_bf16_f32 v115, v54, v55
    s_waitcnt vmcnt(1)
    v_cvt_f32_i32 v56, v56
    v_cvt_f32_i32 v57, v57
    v_cvt_pk_bf16_f32 v116, v56, v57
    v_lshlrev_b32 v56, 16, v116
    v_and_b32 v57, s72, v116
    v_sub_f32 v56, v56, v40
    v_sub_f32 v57, v57, v41
    v_cvt_pk_bf16_f32 v116, v56, v57
    v_lshlrev_b32 v56, 16, v116
    v_and_b32 v57, s72, v116
    v_mul_f32 v56, v56, v32
    v_mul_f32 v57, v57, v33
    v_cvt_pk_bf16_f32 v116, v56, v57
    v_cvt_f32_i32 v58, v58
    v_cvt_f32_i32 v59, v59
    v_cvt_pk_bf16_f32 v117, v58, v59
    v_lshlrev_b32 v58, 16, v117
    v_and_b32 v59, s72, v117
    v_sub_f32 v58, v58, v42
    v_sub_f32 v59, v59, v43
    v_cvt_pk_bf16_f32 v117, v58, v59
    v_lshlrev_b32 v58, 16, v117
    v_and_b32 v59, s72, v117
    v_mul_f32 v58, v58, v34
    v_mul_f32 v59, v59, v35
    v_cvt_pk_bf16_f32 v117, v58, v59
    s_waitcnt vmcnt(0)
    v_cvt_f32_i32 v60, v60
    v_cvt_f32_i32 v61, v61
    v_cvt_pk_bf16_f32 v118, v60, v61
    v_lshlrev_b32 v60, 16, v118
    v_and_b32 v61, s72, v118
    v_sub_f32 v60, v60, v44
    v_sub_f32 v61, v61, v45
    v_cvt_pk_bf16_f32 v118, v60, v61
    v_lshlrev_b32 v60, 16, v118
    v_and_b32 v61, s72, v118
    v_mul_f32 v60, v60, v36
    v_mul_f32 v61, v61, v37
    v_cvt_pk_bf16_f32 v118, v60, v61
    v_cvt_f32_i32 v62, v62
    v_cvt_f32_i32 v63, v63
    v_cvt_pk_bf16_f32 v119, v62, v63
    v_lshlrev_b32 v62, 16, v119
    v_and_b32 v63, s72, v119
    v_sub_f32 v62, v62, v46
    v_sub_f32 v63, v63, v47
    v_cvt_pk_bf16_f32 v119, v62, v63
    v_lshlrev_b32 v62, 16, v119
    v_and_b32 v63, s72, v119
    v_mul_f32 v62, v62, v38
    v_mul_f32 v63, v63, v39
    v_cvt_pk_bf16_f32 v119, v62, v63
    v_mfma_f32_16x16x32_bf16 v[144:147], v[112:115], v[24:27], v[144:147]
    s_nop 0
    v_mfma_f32_16x16x32_bf16 v[148:151], v[116:119], v[24:27], v[148:151]
    buffer_load_dwordx4 v[192:195], v3, s[36:39], s55 offen offset:192
    buffer_load_dwordx4 v[196:199], v3, s[40:43], s55 offen offset:192
    buffer_load_dwordx4 v[48:51], v2, s[24:27], s54 offen offset:384
    buffer_load_dwordx4 v[52:55], v2, s[24:27], s54 offen offset:400
    buffer_load_dwordx4 v[56:59], v2, s[24:27], s54 offen offset:2432
    buffer_load_dwordx4 v[60:63], v2, s[24:27], s54 offen offset:2448
    s_waitcnt vmcnt(5)
    v_lshlrev_b32 v32, 16, v192
    v_and_b32 v33, s72, v192
    v_lshlrev_b32 v34, 16, v193
    v_and_b32 v35, s72, v193
    v_lshlrev_b32 v36, 16, v194
    v_and_b32 v37, s72, v194
    v_lshlrev_b32 v38, 16, v195
    v_and_b32 v39, s72, v195
    s_waitcnt vmcnt(4)
    v_lshlrev_b32 v40, 16, v196
    v_and_b32 v41, s72, v196
    v_lshlrev_b32 v42, 16, v197
    v_and_b32 v43, s72, v197
    v_lshlrev_b32 v44, 16, v198
    v_and_b32 v45, s72, v198
    v_lshlrev_b32 v46, 16, v199
    v_and_b32 v47, s72, v199
    s_waitcnt vmcnt(3)
    v_cvt_f32_i32 v48, v48
    v_cvt_f32_i32 v49, v49
    v_cvt_pk_bf16_f32 v112, v48, v49
    v_lshlrev_b32 v48, 16, v112
    v_and_b32 v49, s72, v112
    v_sub_f32 v48, v48, v40
    v_sub_f32 v49, v49, v41
    v_cvt_pk_bf16_f32 v112, v48, v49
    v_lshlrev_b32 v48, 16, v112
    v_and_b32 v49, s72, v112
    v_mul_f32 v48, v48, v32
    v_mul_f32 v49, v49, v33
    v_cvt_pk_bf16_f32 v112, v48, v49
    v_cvt_f32_i32 v50, v50
    v_cvt_f32_i32 v51, v51
    v_cvt_pk_bf16_f32 v113, v50, v51
    v_lshlrev_b32 v50, 16, v113
    v_and_b32 v51, s72, v113
    v_sub_f32 v50, v50, v42
    v_sub_f32 v51, v51, v43
    v_cvt_pk_bf16_f32 v113, v50, v51
    v_lshlrev_b32 v50, 16, v113
    v_and_b32 v51, s72, v113
    v_mul_f32 v50, v50, v34
    v_mul_f32 v51, v51, v35
    v_cvt_pk_bf16_f32 v113, v50, v51
    s_waitcnt vmcnt(2)
    v_cvt_f32_i32 v52, v52
    v_cvt_f32_i32 v53, v53
    v_cvt_pk_bf16_f32 v114, v52, v53
    v_lshlrev_b32 v52, 16, v114
    v_and_b32 v53, s72, v114
    v_sub_f32 v52, v52, v44
    v_sub_f32 v53, v53, v45
    v_cvt_pk_bf16_f32 v114, v52, v53
    v_lshlrev_b32 v52, 16, v114
    v_and_b32 v53, s72, v114
    v_mul_f32 v52, v52, v36
    v_mul_f32 v53, v53, v37
    v_cvt_pk_bf16_f32 v114, v52, v53
    v_cvt_f32_i32 v54, v54
    v_cvt_f32_i32 v55, v55
    v_cvt_pk_bf16_f32 v115, v54, v55
    v_lshlrev_b32 v54, 16, v115
    v_and_b32 v55, s72, v115
    v_sub_f32 v54, v54, v46
    v_sub_f32 v55, v55, v47
    v_cvt_pk_bf16_f32 v115, v54, v55
    v_lshlrev_b32 v54, 16, v115
    v_and_b32 v55, s72, v115
    v_mul_f32 v54, v54, v38
    v_mul_f32 v55, v55, v39
    v_cvt_pk_bf16_f32 v115, v54, v55
    s_waitcnt vmcnt(1)
    v_cvt_f32_i32 v56, v56
    v_cvt_f32_i32 v57, v57
    v_cvt_pk_bf16_f32 v116, v56, v57
    v_lshlrev_b32 v56, 16, v116
    v_and_b32 v57, s72, v116
    v_sub_f32 v56, v56, v40
    v_sub_f32 v57, v57, v41
    v_cvt_pk_bf16_f32 v116, v56, v57
    v_lshlrev_b32 v56, 16, v116
    v_and_b32 v57, s72, v116
    v_mul_f32 v56, v56, v32
    v_mul_f32 v57, v57, v33
    v_cvt_pk_bf16_f32 v116, v56, v57
    v_cvt_f32_i32 v58, v58
    v_cvt_f32_i32 v59, v59
    v_cvt_pk_bf16_f32 v117, v58, v59
    v_lshlrev_b32 v58, 16, v117
    v_and_b32 v59, s72, v117
    v_sub_f32 v58, v58, v42
    v_sub_f32 v59, v59, v43
    v_cvt_pk_bf16_f32 v117, v58, v59
    v_lshlrev_b32 v58, 16, v117
    v_and_b32 v59, s72, v117
    v_mul_f32 v58, v58, v34
    v_mul_f32 v59, v59, v35
    v_cvt_pk_bf16_f32 v117, v58, v59
    s_waitcnt vmcnt(0)
    v_cvt_f32_i32 v60, v60
    v_cvt_f32_i32 v61, v61
    v_cvt_pk_bf16_f32 v118, v60, v61
    v_lshlrev_b32 v60, 16, v118
    v_and_b32 v61, s72, v118
    v_sub_f32 v60, v60, v44
    v_sub_f32 v61, v61, v45
    v_cvt_pk_bf16_f32 v118, v60, v61
    v_lshlrev_b32 v60, 16, v118
    v_and_b32 v61, s72, v118
    v_mul_f32 v60, v60, v36
    v_mul_f32 v61, v61, v37
    v_cvt_pk_bf16_f32 v118, v60, v61
    v_cvt_f32_i32 v62, v62
    v_cvt_f32_i32 v63, v63
    v_cvt_pk_bf16_f32 v119, v62, v63
    v_lshlrev_b32 v62, 16, v119
    v_and_b32 v63, s72, v119
    v_sub_f32 v62, v62, v46
    v_sub_f32 v63, v63, v47
    v_cvt_pk_bf16_f32 v119, v62, v63
    v_lshlrev_b32 v62, 16, v119
    v_and_b32 v63, s72, v119
    v_mul_f32 v62, v62, v38
    v_mul_f32 v63, v63, v39
    v_cvt_pk_bf16_f32 v119, v62, v63
    v_mfma_f32_16x16x32_bf16 v[144:147], v[112:115], v[28:31], v[144:147]
    s_nop 0
    v_mfma_f32_16x16x32_bf16 v[148:151], v[116:119], v[28:31], v[148:151]
    buffer_load_dwordx4 v[192:195], v3, s[44:47], s61 offen
    buffer_load_dwordx4 v[196:199], v3, s[48:51], s61 offen
    buffer_load_dwordx4 v[48:51], v4, s[28:31], s54 offen
    buffer_load_dwordx4 v[52:55], v4, s[28:31], s54 offen offset:16
    buffer_load_dwordx4 v[56:59], v4, s[28:31], s54 offen offset:512
    buffer_load_dwordx4 v[60:63], v4, s[28:31], s54 offen offset:528
    buffer_load_dwordx4 v[64:67], v4, s[28:31], s54 offen offset:1024
    buffer_load_dwordx4 v[68:71], v4, s[28:31], s54 offen offset:1040
    buffer_load_dwordx4 v[72:75], v4, s[28:31], s54 offen offset:1536
    buffer_load_dwordx4 v[76:79], v4, s[28:31], s54 offen offset:1552
    buffer_load_dwordx4 v[80:83], v4, s[28:31], s54 offen offset:2048
    buffer_load_dwordx4 v[84:87], v4, s[28:31], s54 offen offset:2064
    buffer_load_dwordx4 v[88:91], v4, s[28:31], s54 offen offset:2560
    buffer_load_dwordx4 v[92:95], v4, s[28:31], s54 offen offset:2576
    buffer_load_dwordx4 v[96:99], v4, s[28:31], s54 offen offset:3072
    buffer_load_dwordx4 v[100:103], v4, s[28:31], s54 offen offset:3088
    buffer_load_dwordx4 v[104:107], v4, s[28:31], s54 offen offset:3584
    buffer_load_dwordx4 v[108:111], v4, s[28:31], s54 offen offset:3600
    v_mul_f32 v144, s70, v144
    v_mul_f32 v145, s70, v145
    v_mul_f32 v146, s70, v146
    v_mul_f32 v147, s70, v147
    v_mul_f32 v148, s70, v148
    v_mul_f32 v149, s70, v149
    v_mul_f32 v150, s70, v150
    v_mul_f32 v151, s70, v151
    v_max3_f32 v10, v144, v145, v146
    v_max3_f32 v10, v10, v147, v148
    v_max3_f32 v10, v10, v149, v150
    v_max3_f32 v10, v10, v151, v7
    v_mov_b32 v12, v10
    s_nop 1
    v_permlane16_swap_b32 v10, v12
    v_max_f32 v10, v10, v12
    v_mov_b32 v12, v10
    s_nop 1
    v_permlane32_swap_b32 v10, v12
    v_max_f32 v10, v10, v12
    v_max_f32 v12, 0xff7fffff, v10
    v_sub_f32 v9, v7, v12
    v_mov_b32 v7, v10
    v_exp_f32 v9, v9
    v_sub_f32 v144, v144, v12
    v_sub_f32 v145, v145, v12
    v_sub_f32 v146, v146, v12
    v_sub_f32 v147, v147, v12
    v_sub_f32 v148, v148, v12
    v_sub_f32 v149, v149, v12
    v_sub_f32 v150, v150, v12
    v_sub_f32 v151, v151, v12
    v_exp_f32 v144, v144
    v_exp_f32 v145, v145
    v_exp_f32 v146, v146
    v_exp_f32 v147, v147
    v_exp_f32 v148, v148
    v_exp_f32 v149, v149
    v_exp_f32 v150, v150
    v_exp_f32 v151, v151
    v_mul_f32 v8, v8, v9
    v_add_f32 v8, v8, v144
    v_add_f32 v8, v8, v145
    v_add_f32 v8, v8, v146
    v_add_f32 v8, v8, v147
    v_add_f32 v8, v8, v148
    v_add_f32 v8, v8, v149
    v_add_f32 v8, v8, v150
    v_add_f32 v8, v8, v151
    v_cvt_pk_bf16_f32 v152, v144, v145
    v_cvt_pk_bf16_f32 v153, v146, v147
    v_cvt_pk_bf16_f32 v154, v148, v149
    v_cvt_pk_bf16_f32 v155, v150, v151
    v_mul_f32 v160, v160, v9
    v_mul_f32 v161, v161, v9
    v_mul_f32 v162, v162, v9
    v_mul_f32 v163, v163, v9
    v_mul_f32 v164, v164, v9
    v_mul_f32 v165, v165, v9
    v_mul_f32 v166, v166, v9
    v_mul_f32 v167, v167, v9
    v_mul_f32 v168, v168, v9
    v_mul_f32 v169, v169, v9
    v_mul_f32 v170, v170, v9
    v_mul_f32 v171, v171, v9
    v_mul_f32 v172, v172, v9
    v_mul_f32 v173, v173, v9
    v_mul_f32 v174, v174, v9
    v_mul_f32 v175, v175, v9
    v_mul_f32 v176, v176, v9
    v_mul_f32 v177, v177, v9
    v_mul_f32 v178, v178, v9
    v_mul_f32 v179, v179, v9
    v_mul_f32 v180, v180, v9
    v_mul_f32 v181, v181, v9
    v_mul_f32 v182, v182, v9
    v_mul_f32 v183, v183, v9
    v_mul_f32 v184, v184, v9
    v_mul_f32 v185, v185, v9
    v_mul_f32 v186, v186, v9
    v_mul_f32 v187, v187, v9
    v_mul_f32 v188, v188, v9
    v_mul_f32 v189, v189, v9
    v_mul_f32 v190, v190, v9
    v_mul_f32 v191, v191, v9
    s_waitcnt vmcnt(17)
    v_lshlrev_b32 v32, 16, v192
    v_and_b32 v33, s72, v192
    v_lshlrev_b32 v34, 16, v193
    v_and_b32 v35, s72, v193
    v_lshlrev_b32 v36, 16, v194
    v_and_b32 v37, s72, v194
    v_lshlrev_b32 v38, 16, v195
    v_and_b32 v39, s72, v195
    s_waitcnt vmcnt(16)
    v_lshlrev_b32 v40, 16, v196
    v_and_b32 v41, s72, v196
    v_lshlrev_b32 v42, 16, v197
    v_and_b32 v43, s72, v197
    v_lshlrev_b32 v44, 16, v198
    v_and_b32 v45, s72, v198
    v_lshlrev_b32 v46, 16, v199
    v_and_b32 v47, s72, v199
    s_waitcnt vmcnt(15)
    v_cvt_f32_i32 v48, v48
    s_waitcnt vmcnt(13)
    v_cvt_f32_i32 v56, v56
    v_cvt_pk_bf16_f32 v112, v48, v56
    v_lshlrev_b32 v48, 16, v112
    v_and_b32 v56, s72, v112
    v_sub_f32 v48, v48, v40
    v_sub_f32 v56, v56, v41
    v_cvt_pk_bf16_f32 v112, v48, v56
    v_lshlrev_b32 v48, 16, v112
    v_and_b32 v56, s72, v112
    v_mul_f32 v48, v48, v32
    v_mul_f32 v56, v56, v33
    v_cvt_pk_bf16_f32 v112, v48, v56
    s_waitcnt vmcnt(11)
    v_cvt_f32_i32 v64, v64
    s_waitcnt vmcnt(9)
    v_cvt_f32_i32 v72, v72
    v_cvt_pk_bf16_f32 v113, v64, v72
    v_lshlrev_b32 v64, 16, v113
    v_and_b32 v72, s72, v113
    v_sub_f32 v64, v64, v42
    v_sub_f32 v72, v72, v43
    v_cvt_pk_bf16_f32 v113, v64, v72
    v_lshlrev_b32 v64, 16, v113
    v_and_b32 v72, s72, v113
    v_mul_f32 v64, v64, v34
    v_mul_f32 v72, v72, v35
    v_cvt_pk_bf16_f32 v113, v64, v72
    s_waitcnt vmcnt(7)
    v_cvt_f32_i32 v80, v80
    s_waitcnt vmcnt(5)
    v_cvt_f32_i32 v88, v88
    v_cvt_pk_bf16_f32 v114, v80, v88
    v_lshlrev_b32 v80, 16, v114
    v_and_b32 v88, s72, v114
    v_sub_f32 v80, v80, v44
    v_sub_f32 v88, v88, v45
    v_cvt_pk_bf16_f32 v114, v80, v88
    v_lshlrev_b32 v80, 16, v114
    v_and_b32 v88, s72, v114
    v_mul_f32 v80, v80, v36
    v_mul_f32 v88, v88, v37
    v_cvt_pk_bf16_f32 v114, v80, v88
    s_waitcnt vmcnt(3)
    v_cvt_f32_i32 v96, v96
    s_waitcnt vmcnt(1)
    v_cvt_f32_i32 v104, v104
    v_cvt_pk_bf16_f32 v115, v96, v104
    v_lshlrev_b32 v96, 16, v115
    v_and_b32 v104, s72, v115
    v_sub_f32 v96, v96, v46
    v_sub_f32 v104, v104, v47
    v_cvt_pk_bf16_f32 v115, v96, v104
    v_lshlrev_b32 v96, 16, v115
    v_and_b32 v104, s72, v115
    v_mul_f32 v96, v96, v38
    v_mul_f32 v104, v104, v39
    v_cvt_pk_bf16_f32 v115, v96, v104
    v_cvt_f32_i32 v49, v49
    v_cvt_f32_i32 v57, v57
    v_cvt_pk_bf16_f32 v116, v49, v57
    v_lshlrev_b32 v49, 16, v116
    v_and_b32 v57, s72, v116
    v_sub_f32 v49, v49, v40
    v_sub_f32 v57, v57, v41
    v_cvt_pk_bf16_f32 v116, v49, v57
    v_lshlrev_b32 v49, 16, v116
    v_and_b32 v57, s72, v116
    v_mul_f32 v49, v49, v32
    v_mul_f32 v57, v57, v33
    v_cvt_pk_bf16_f32 v116, v49, v57
    v_cvt_f32_i32 v65, v65
    v_cvt_f32_i32 v73, v73
    v_cvt_pk_bf16_f32 v117, v65, v73
    v_lshlrev_b32 v65, 16, v117
    v_and_b32 v73, s72, v117
    v_sub_f32 v65, v65, v42
    v_sub_f32 v73, v73, v43
    v_cvt_pk_bf16_f32 v117, v65, v73
    v_lshlrev_b32 v65, 16, v117
    v_and_b32 v73, s72, v117
    v_mul_f32 v65, v65, v34
    v_mul_f32 v73, v73, v35
    v_cvt_pk_bf16_f32 v117, v65, v73
    v_cvt_f32_i32 v81, v81
    v_cvt_f32_i32 v89, v89
    v_cvt_pk_bf16_f32 v118, v81, v89
    v_lshlrev_b32 v81, 16, v118
    v_and_b32 v89, s72, v118
    v_sub_f32 v81, v81, v44
    v_sub_f32 v89, v89, v45
    v_cvt_pk_bf16_f32 v118, v81, v89
    v_lshlrev_b32 v81, 16, v118
    v_and_b32 v89, s72, v118
    v_mul_f32 v81, v81, v36
    v_mul_f32 v89, v89, v37
    v_cvt_pk_bf16_f32 v118, v81, v89
    v_cvt_f32_i32 v97, v97
    v_cvt_f32_i32 v105, v105
    v_cvt_pk_bf16_f32 v119, v97, v105
    v_lshlrev_b32 v97, 16, v119
    v_and_b32 v105, s72, v119
    v_sub_f32 v97, v97, v46
    v_sub_f32 v105, v105, v47
    v_cvt_pk_bf16_f32 v119, v97, v105
    v_lshlrev_b32 v97, 16, v119
    v_and_b32 v105, s72, v119
    v_mul_f32 v97, v97, v38
    v_mul_f32 v105, v105, v39
    v_cvt_pk_bf16_f32 v119, v97, v105
    v_cvt_f32_i32 v50, v50
    v_cvt_f32_i32 v58, v58
    v_cvt_pk_bf16_f32 v120, v50, v58
    v_lshlrev_b32 v50, 16, v120
    v_and_b32 v58, s72, v120
    v_sub_f32 v50, v50, v40
    v_sub_f32 v58, v58, v41
    v_cvt_pk_bf16_f32 v120, v50, v58
    v_lshlrev_b32 v50, 16, v120
    v_and_b32 v58, s72, v120
    v_mul_f32 v50, v50, v32
    v_mul_f32 v58, v58, v33
    v_cvt_pk_bf16_f32 v120, v50, v58
    v_cvt_f32_i32 v66, v66
    v_cvt_f32_i32 v74, v74
    v_cvt_pk_bf16_f32 v121, v66, v74
    v_lshlrev_b32 v66, 16, v121
    v_and_b32 v74, s72, v121
    v_sub_f32 v66, v66, v42
    v_sub_f32 v74, v74, v43
    v_cvt_pk_bf16_f32 v121, v66, v74
    v_lshlrev_b32 v66, 16, v121
    v_and_b32 v74, s72, v121
    v_mul_f32 v66, v66, v34
    v_mul_f32 v74, v74, v35
    v_cvt_pk_bf16_f32 v121, v66, v74
    v_cvt_f32_i32 v82, v82
    v_cvt_f32_i32 v90, v90
    v_cvt_pk_bf16_f32 v122, v82, v90
    v_lshlrev_b32 v82, 16, v122
    v_and_b32 v90, s72, v122
    v_sub_f32 v82, v82, v44
    v_sub_f32 v90, v90, v45
    v_cvt_pk_bf16_f32 v122, v82, v90
    v_lshlrev_b32 v82, 16, v122
    v_and_b32 v90, s72, v122
    v_mul_f32 v82, v82, v36
    v_mul_f32 v90, v90, v37
    v_cvt_pk_bf16_f32 v122, v82, v90
    v_cvt_f32_i32 v98, v98
    v_cvt_f32_i32 v106, v106
    v_cvt_pk_bf16_f32 v123, v98, v106
    v_lshlrev_b32 v98, 16, v123
    v_and_b32 v106, s72, v123
    v_sub_f32 v98, v98, v46
    v_sub_f32 v106, v106, v47
    v_cvt_pk_bf16_f32 v123, v98, v106
    v_lshlrev_b32 v98, 16, v123
    v_and_b32 v106, s72, v123
    v_mul_f32 v98, v98, v38
    v_mul_f32 v106, v106, v39
    v_cvt_pk_bf16_f32 v123, v98, v106
    v_cvt_f32_i32 v51, v51
    v_cvt_f32_i32 v59, v59
    v_cvt_pk_bf16_f32 v124, v51, v59
    v_lshlrev_b32 v51, 16, v124
    v_and_b32 v59, s72, v124
    v_sub_f32 v51, v51, v40
    v_sub_f32 v59, v59, v41
    v_cvt_pk_bf16_f32 v124, v51, v59
    v_lshlrev_b32 v51, 16, v124
    v_and_b32 v59, s72, v124
    v_mul_f32 v51, v51, v32
    v_mul_f32 v59, v59, v33
    v_cvt_pk_bf16_f32 v124, v51, v59
    v_cvt_f32_i32 v67, v67
    v_cvt_f32_i32 v75, v75
    v_cvt_pk_bf16_f32 v125, v67, v75
    v_lshlrev_b32 v67, 16, v125
    v_and_b32 v75, s72, v125
    v_sub_f32 v67, v67, v42
    v_sub_f32 v75, v75, v43
    v_cvt_pk_bf16_f32 v125, v67, v75
    v_lshlrev_b32 v67, 16, v125
    v_and_b32 v75, s72, v125
    v_mul_f32 v67, v67, v34
    v_mul_f32 v75, v75, v35
    v_cvt_pk_bf16_f32 v125, v67, v75
    v_cvt_f32_i32 v83, v83
    v_cvt_f32_i32 v91, v91
    v_cvt_pk_bf16_f32 v126, v83, v91
    v_lshlrev_b32 v83, 16, v126
    v_and_b32 v91, s72, v126
    v_sub_f32 v83, v83, v44
    v_sub_f32 v91, v91, v45
    v_cvt_pk_bf16_f32 v126, v83, v91
    v_lshlrev_b32 v83, 16, v126
    v_and_b32 v91, s72, v126
    v_mul_f32 v83, v83, v36
    v_mul_f32 v91, v91, v37
    v_cvt_pk_bf16_f32 v126, v83, v91
    v_cvt_f32_i32 v99, v99
    v_cvt_f32_i32 v107, v107
    v_cvt_pk_bf16_f32 v127, v99, v107
    v_lshlrev_b32 v99, 16, v127
    v_and_b32 v107, s72, v127
    v_sub_f32 v99, v99, v46
    v_sub_f32 v107, v107, v47
    v_cvt_pk_bf16_f32 v127, v99, v107
    v_lshlrev_b32 v99, 16, v127
    v_and_b32 v107, s72, v127
    v_mul_f32 v99, v99, v38
    v_mul_f32 v107, v107, v39
    v_cvt_pk_bf16_f32 v127, v99, v107
    v_cvt_f32_i32 v52, v52
    v_cvt_f32_i32 v60, v60
    v_cvt_pk_bf16_f32 v128, v52, v60
    v_lshlrev_b32 v52, 16, v128
    v_and_b32 v60, s72, v128
    v_sub_f32 v52, v52, v40
    v_sub_f32 v60, v60, v41
    v_cvt_pk_bf16_f32 v128, v52, v60
    v_lshlrev_b32 v52, 16, v128
    v_and_b32 v60, s72, v128
    v_mul_f32 v52, v52, v32
    v_mul_f32 v60, v60, v33
    v_cvt_pk_bf16_f32 v128, v52, v60
    v_cvt_f32_i32 v68, v68
    v_cvt_f32_i32 v76, v76
    v_cvt_pk_bf16_f32 v129, v68, v76
    v_lshlrev_b32 v68, 16, v129
    v_and_b32 v76, s72, v129
    v_sub_f32 v68, v68, v42
    v_sub_f32 v76, v76, v43
    v_cvt_pk_bf16_f32 v129, v68, v76
    v_lshlrev_b32 v68, 16, v129
    v_and_b32 v76, s72, v129
    v_mul_f32 v68, v68, v34
    v_mul_f32 v76, v76, v35
    v_cvt_pk_bf16_f32 v129, v68, v76
    v_cvt_f32_i32 v84, v84
    v_cvt_f32_i32 v92, v92
    v_cvt_pk_bf16_f32 v130, v84, v92
    v_lshlrev_b32 v84, 16, v130
    v_and_b32 v92, s72, v130
    v_sub_f32 v84, v84, v44
    v_sub_f32 v92, v92, v45
    v_cvt_pk_bf16_f32 v130, v84, v92
    v_lshlrev_b32 v84, 16, v130
    v_and_b32 v92, s72, v130
    v_mul_f32 v84, v84, v36
    v_mul_f32 v92, v92, v37
    v_cvt_pk_bf16_f32 v130, v84, v92
    v_cvt_f32_i32 v100, v100
    s_waitcnt vmcnt(0)
    v_cvt_f32_i32 v108, v108
    v_cvt_pk_bf16_f32 v131, v100, v108
    v_lshlrev_b32 v100, 16, v131
    v_and_b32 v108, s72, v131
    v_sub_f32 v100, v100, v46
    v_sub_f32 v108, v108, v47
    v_cvt_pk_bf16_f32 v131, v100, v108
    v_lshlrev_b32 v100, 16, v131
    v_and_b32 v108, s72, v131
    v_mul_f32 v100, v100, v38
    v_mul_f32 v108, v108, v39
    v_cvt_pk_bf16_f32 v131, v100, v108
    v_cvt_f32_i32 v53, v53
    v_cvt_f32_i32 v61, v61
    v_cvt_pk_bf16_f32 v132, v53, v61
    v_lshlrev_b32 v53, 16, v132
    v_and_b32 v61, s72, v132
    v_sub_f32 v53, v53, v40
    v_sub_f32 v61, v61, v41
    v_cvt_pk_bf16_f32 v132, v53, v61
    v_lshlrev_b32 v53, 16, v132
    v_and_b32 v61, s72, v132
    v_mul_f32 v53, v53, v32
    v_mul_f32 v61, v61, v33
    v_cvt_pk_bf16_f32 v132, v53, v61
    v_cvt_f32_i32 v69, v69
    v_cvt_f32_i32 v77, v77
    v_cvt_pk_bf16_f32 v133, v69, v77
    v_lshlrev_b32 v69, 16, v133
    v_and_b32 v77, s72, v133
    v_sub_f32 v69, v69, v42
    v_sub_f32 v77, v77, v43
    v_cvt_pk_bf16_f32 v133, v69, v77
    v_lshlrev_b32 v69, 16, v133
    v_and_b32 v77, s72, v133
    v_mul_f32 v69, v69, v34
    v_mul_f32 v77, v77, v35
    v_cvt_pk_bf16_f32 v133, v69, v77
    v_cvt_f32_i32 v85, v85
    v_cvt_f32_i32 v93, v93
    v_cvt_pk_bf16_f32 v134, v85, v93
    v_lshlrev_b32 v85, 16, v134
    v_and_b32 v93, s72, v134
    v_sub_f32 v85, v85, v44
    v_sub_f32 v93, v93, v45
    v_cvt_pk_bf16_f32 v134, v85, v93
    v_lshlrev_b32 v85, 16, v134
    v_and_b32 v93, s72, v134
    v_mul_f32 v85, v85, v36
    v_mul_f32 v93, v93, v37
    v_cvt_pk_bf16_f32 v134, v85, v93
    v_cvt_f32_i32 v101, v101
    v_cvt_f32_i32 v109, v109
    v_cvt_pk_bf16_f32 v135, v101, v109
    v_lshlrev_b32 v101, 16, v135
    v_and_b32 v109, s72, v135
    v_sub_f32 v101, v101, v46
    v_sub_f32 v109, v109, v47
    v_cvt_pk_bf16_f32 v135, v101, v109
    v_lshlrev_b32 v101, 16, v135
    v_and_b32 v109, s72, v135
    v_mul_f32 v101, v101, v38
    v_mul_f32 v109, v109, v39
    v_cvt_pk_bf16_f32 v135, v101, v109
    v_cvt_f32_i32 v54, v54
    v_cvt_f32_i32 v62, v62
    v_cvt_pk_bf16_f32 v136, v54, v62
    v_lshlrev_b32 v54, 16, v136
    v_and_b32 v62, s72, v136
    v_sub_f32 v54, v54, v40
    v_sub_f32 v62, v62, v41
    v_cvt_pk_bf16_f32 v136, v54, v62
    v_lshlrev_b32 v54, 16, v136
    v_and_b32 v62, s72, v136
    v_mul_f32 v54, v54, v32
    v_mul_f32 v62, v62, v33
    v_cvt_pk_bf16_f32 v136, v54, v62
    v_cvt_f32_i32 v70, v70
    v_cvt_f32_i32 v78, v78
    v_cvt_pk_bf16_f32 v137, v70, v78
    v_lshlrev_b32 v70, 16, v137
    v_and_b32 v78, s72, v137
    v_sub_f32 v70, v70, v42
    v_sub_f32 v78, v78, v43
    v_cvt_pk_bf16_f32 v137, v70, v78
    v_lshlrev_b32 v70, 16, v137
    v_and_b32 v78, s72, v137
    v_mul_f32 v70, v70, v34
    v_mul_f32 v78, v78, v35
    v_cvt_pk_bf16_f32 v137, v70, v78
    v_cvt_f32_i32 v86, v86
    v_cvt_f32_i32 v94, v94
    v_cvt_pk_bf16_f32 v138, v86, v94
    v_lshlrev_b32 v86, 16, v138
    v_and_b32 v94, s72, v138
    v_sub_f32 v86, v86, v44
    v_sub_f32 v94, v94, v45
    v_cvt_pk_bf16_f32 v138, v86, v94
    v_lshlrev_b32 v86, 16, v138
    v_and_b32 v94, s72, v138
    v_mul_f32 v86, v86, v36
    v_mul_f32 v94, v94, v37
    v_cvt_pk_bf16_f32 v138, v86, v94
    v_cvt_f32_i32 v102, v102
    v_cvt_f32_i32 v110, v110
    v_cvt_pk_bf16_f32 v139, v102, v110
    v_lshlrev_b32 v102, 16, v139
    v_and_b32 v110, s72, v139
    v_sub_f32 v102, v102, v46
    v_sub_f32 v110, v110, v47
    v_cvt_pk_bf16_f32 v139, v102, v110
    v_lshlrev_b32 v102, 16, v139
    v_and_b32 v110, s72, v139
    v_mul_f32 v102, v102, v38
    v_mul_f32 v110, v110, v39
    v_cvt_pk_bf16_f32 v139, v102, v110
    v_cvt_f32_i32 v55, v55
    v_cvt_f32_i32 v63, v63
    v_cvt_pk_bf16_f32 v140, v55, v63
    v_lshlrev_b32 v55, 16, v140
    v_and_b32 v63, s72, v140
    v_sub_f32 v55, v55, v40
    v_sub_f32 v63, v63, v41
    v_cvt_pk_bf16_f32 v140, v55, v63
    v_lshlrev_b32 v55, 16, v140
    v_and_b32 v63, s72, v140
    v_mul_f32 v55, v55, v32
    v_mul_f32 v63, v63, v33
    v_cvt_pk_bf16_f32 v140, v55, v63
    v_cvt_f32_i32 v71, v71
    v_cvt_f32_i32 v79, v79
    v_cvt_pk_bf16_f32 v141, v71, v79
    v_lshlrev_b32 v71, 16, v141
    v_and_b32 v79, s72, v141
    v_sub_f32 v71, v71, v42
    v_sub_f32 v79, v79, v43
    v_cvt_pk_bf16_f32 v141, v71, v79
    v_lshlrev_b32 v71, 16, v141
    v_and_b32 v79, s72, v141
    v_mul_f32 v71, v71, v34
    v_mul_f32 v79, v79, v35
    v_cvt_pk_bf16_f32 v141, v71, v79
    v_cvt_f32_i32 v87, v87
    v_cvt_f32_i32 v95, v95
    v_cvt_pk_bf16_f32 v142, v87, v95
    v_lshlrev_b32 v87, 16, v142
    v_and_b32 v95, s72, v142
    v_sub_f32 v87, v87, v44
    v_sub_f32 v95, v95, v45
    v_cvt_pk_bf16_f32 v142, v87, v95
    v_lshlrev_b32 v87, 16, v142
    v_and_b32 v95, s72, v142
    v_mul_f32 v87, v87, v36
    v_mul_f32 v95, v95, v37
    v_cvt_pk_bf16_f32 v142, v87, v95
    v_cvt_f32_i32 v103, v103
    v_cvt_f32_i32 v111, v111
    v_cvt_pk_bf16_f32 v143, v103, v111
    v_lshlrev_b32 v103, 16, v143
    v_and_b32 v111, s72, v143
    v_sub_f32 v103, v103, v46
    v_sub_f32 v111, v111, v47
    v_cvt_pk_bf16_f32 v143, v103, v111
    v_lshlrev_b32 v103, 16, v143
    v_and_b32 v111, s72, v143
    v_mul_f32 v103, v103, v38
    v_mul_f32 v111, v111, v39
    v_cvt_pk_bf16_f32 v143, v103, v111
    v_mfma_f32_16x16x32_bf16 v[160:163], v[112:115], v[152:155], v[160:163]
    v_mfma_f32_16x16x32_bf16 v[164:167], v[116:119], v[152:155], v[164:167]
    v_mfma_f32_16x16x32_bf16 v[168:171], v[120:123], v[152:155], v[168:171]
    v_mfma_f32_16x16x32_bf16 v[172:175], v[124:127], v[152:155], v[172:175]
    v_mfma_f32_16x16x32_bf16 v[176:179], v[128:131], v[152:155], v[176:179]
    v_mfma_f32_16x16x32_bf16 v[180:183], v[132:135], v[152:155], v[180:183]
    v_mfma_f32_16x16x32_bf16 v[184:187], v[136:139], v[152:155], v[184:187]
    v_mfma_f32_16x16x32_bf16 v[188:191], v[140:143], v[152:155], v[188:191]
    s_nop 7
    s_add_u32 s53, s53, 1
    s_cmp_lt_u32 s53, 64
    s_cbranch_scc1 L_slow_s
    v_mov_b32 v12, v8
    s_nop 1
    v_permlane16_swap_b32 v8, v12
    v_add_f32 v8, v8, v12
    v_mov_b32 v12, v8
    s_nop 1
    v_permlane32_swap_b32 v8, v12
    v_add_f32 v8, v8, v12
    v_rcp_f32 v8, v8
    s_nop 0
    v_mul_f32 v160, v160, v8
    v_mul_f32 v161, v161, v8
    v_mul_f32 v162, v162, v8
    v_mul_f32 v163, v163, v8
    v_mul_f32 v164, v164, v8
    v_mul_f32 v165, v165, v8
    v_mul_f32 v166, v166, v8
    v_mul_f32 v167, v167, v8
    v_mul_f32 v168, v168, v8
    v_mul_f32 v169, v169, v8
    v_mul_f32 v170, v170, v8
    v_mul_f32 v171, v171, v8
    v_mul_f32 v172, v172, v8
    v_mul_f32 v173, v173, v8
    v_mul_f32 v174, v174, v8
    v_mul_f32 v175, v175, v8
    v_mul_f32 v176, v176, v8
    v_mul_f32 v177, v177, v8
    v_mul_f32 v178, v178, v8
    v_mul_f32 v179, v179, v8
    v_mul_f32 v180, v180, v8
    v_mul_f32 v181, v181, v8
    v_mul_f32 v182, v182, v8
    v_mul_f32 v183, v183, v8
    v_mul_f32 v184, v184, v8
    v_mul_f32 v185, v185, v8
    v_mul_f32 v186, v186, v8
    v_mul_f32 v187, v187, v8
    v_mul_f32 v188, v188, v8
    v_mul_f32 v189, v189, v8
    v_mul_f32 v190, v190, v8
    v_mul_f32 v191, v191, v8
    v_cvt_pk_bf16_f32 v112, v160, v164
    v_cvt_pk_bf16_f32 v113, v168, v172
    v_cvt_pk_bf16_f32 v114, v176, v180
    v_cvt_pk_bf16_f32 v115, v184, v188
    buffer_store_dwordx4 v[112:115], v6, s[32:35], s52 offen
    v_cvt_pk_bf16_f32 v116, v161, v165
    v_cvt_pk_bf16_f32 v117, v169, v173
    v_cvt_pk_bf16_f32 v118, v177, v181
    v_cvt_pk_bf16_f32 v119, v185, v189
    buffer_store_dwordx4 v[116:119], v6, s[32:35], s52 offen offset:16
    v_cvt_pk_bf16_f32 v120, v162, v166
    v_cvt_pk_bf16_f32 v121, v170, v174
    v_cvt_pk_bf16_f32 v122, v178, v182
    v_cvt_pk_bf16_f32 v123, v186, v190
    buffer_store_dwordx4 v[120:123], v6, s[32:35], s52 offen offset:32
    v_cvt_pk_bf16_f32 v124, v163, v167
    v_cvt_pk_bf16_f32 v125, v171, v175
    v_cvt_pk_bf16_f32 v126, v179, v183
    v_cvt_pk_bf16_f32 v127, v187, v191
    buffer_store_dwordx4 v[124:127], v6, s[32:35], s52 offen offset:48
    s_waitcnt vmcnt(0)
    s_add_u32 s52, s52, 0x1000
    s_cmp_lt_u32 s52, 0x4000
    s_cbranch_scc1 L_slow_q
    s_endpgm
.section .rodata,"a"
.p2align 6
.amdhsa_kernel standalone__kv_cache_quant_int4_int2_kv_with_per_channel_or_per_token_scales__prompt_kernel
  .amdhsa_next_free_vgpr 468
  .amdhsa_next_free_sgpr 100
  .amdhsa_accum_offset 256
  .amdhsa_group_segment_fixed_size 0
  .amdhsa_kernarg_size 80
  .amdhsa_user_sgpr_count 2
  .amdhsa_user_sgpr_kernarg_segment_ptr 1
  .amdhsa_system_sgpr_workgroup_id_x 1
  .amdhsa_float_denorm_mode_32 3
.end_amdhsa_kernel
```
